```python
import torch

def _softmax(x, axis=-1):
    return torch.softmax(x, dim=axis)
def _gelu(x):
    return torch.nn.functional.gelu(x, approximate="tanh")
def _silu(x):
    return torch.nn.functional.silu(x)
def _sigmoid(x):
    return torch.sigmoid(x)
def _layernorm(x, axis=-1, eps=1e-5):
    m = x.mean(dim=axis, keepdim=True)
    v = x.var(dim=axis, keepdim=True, unbiased=False)
    return (x - m) / torch.sqrt(v + eps)
def _scatter_add(tgt, idx, src, axis=0):
    return tgt.clone().index_add_(axis, idx, src)
def _segment_sum(src, seg, n):
    out = torch.zeros((n,) + src.shape[1:], dtype=src.dtype)
    return out.index_add_(0, seg, src)
def _pad(x, pw):
    flat = tuple(v for pair in reversed(pw) for v in pair)
    return torch.nn.functional.pad(x, flat)

kernel_name = 'parallel_sum__mha_block_cached__geglu_ffn__decode'

def setup_inputs():

    _w = (lambda a: (lambda t: t.to(torch.bfloat16) if t.is_floating_point() else t)(torch.as_tensor(a)))
    def _A_setup():
        B, Sq, D = 1, 1, 512
        H, Sk, Dh = 32, 32768, 128
        return {
            "x": _w((lambda *s: torch.randn(*s, dtype=torch.bfloat16) * 0.05)(B, Sq, D)),
            "k_cache": _w((lambda *s: torch.randn(*s, dtype=torch.bfloat16) * 3.2)(B, H, Sk, Dh)),
            "v_cache": _w((lambda *s: torch.randn(*s, dtype=torch.bfloat16) * 1.6)(B, H, Sk, Dh)),
            "wq": _w((lambda *s: torch.randn(*s, dtype=torch.bfloat16) * 3.2)(D, H * Dh) * (D ** -0.5)),
            "wo": _w((lambda *s: torch.randn(*s, dtype=torch.bfloat16) * 1.6)(H * Dh, D) * ((H * Dh) ** -0.5)),
        }
    _A_in = _A_setup()

    def _B_setup():
        B, S, D, F = 1, 1, 512, 1376
        return {
            "x": _w((lambda *s: torch.randn(*s, dtype=torch.bfloat16) * 0.05)(B, S, D)),
            "w_gate": _w((lambda *s: torch.randn(*s, dtype=torch.bfloat16) * 0.05)(D, F)),
            "w_up": _w((lambda *s: torch.randn(*s, dtype=torch.bfloat16) * 0.05)(D, F)),
            "w_down": _w((lambda *s: torch.randn(*s, dtype=torch.bfloat16) * 0.05)(F, D)),
        }
    _B_in = _B_setup()

    return {
        "A_x": _A_in["x"],
        "A_k_cache": _A_in["k_cache"],
        "A_v_cache": _A_in["v_cache"],
        "A_wq": _A_in["wq"],
        "A_wo": _A_in["wo"],
        "B_x": _B_in["x"],
        "B_w_gate": _B_in["w_gate"],
        "B_w_up": _B_in["w_up"],
        "B_w_down": _B_in["w_down"],
    }

def reference(A_x, A_k_cache, A_v_cache, A_wq, A_wo, B_x, B_w_gate, B_w_up, B_w_down):
    def _A_ref(x, k_cache, v_cache, wq, wo):
        B, Sq, D = x.shape
        H, Dh = 32, 128
        q = (lambda x, *d: x.permute(*d))((x @ wq).reshape(B, Sq, H, Dh), 0, 2, 1, 3)
        scores = torch.einsum("bhqd,bhkd->bhqk", q, k_cache) * (Dh ** -0.5)
        p = _softmax(scores, axis=-1)
        o = torch.einsum("bhqk,bhkd->bhqd", p, v_cache)
        return (lambda x, *d: x.permute(*d))(o, 0, 2, 1, 3).reshape(B, Sq, H * Dh) @ wo

    def _B_ref(x, w_gate, w_up, w_down):
        return (_gelu(x @ w_gate) * (x @ w_up)) @ w_down

    x = A_x
    xn = _layernorm(x, axis=-1)
    return x + _A_ref(xn, A_k_cache, A_v_cache, A_wq, A_wo) + _B_ref(xn, B_w_gate, B_w_up, B_w_down)
```

```asm
; @launch grid=(256,1,1) block=(1024,1,1) lds=51968
.amdgcn_target "amdgcn-amd-amdhsa--gfx950"
.text
.globl parallel_sum__mha_block_cached__geglu_ffn__decode_kernel
.p2align 8
.type parallel_sum__mha_block_cached__geglu_ffn__decode_kernel,@function
parallel_sum__mha_block_cached__geglu_ffn__decode_kernel:
    s_cmp_ge_u32 s2, 256
    s_cbranch_scc1 L_end
    s_load_dwordx16 s[4:19], s[0:1], 0
    s_load_dwordx8 s[20:27], s[0:1], 64
    v_lshrrev_b32 v2, 6, v0
    v_and_b32 v0, 63, v0
    v_readfirstlane_b32 s3, v2
    v_lshlrev_b32 v1, 4, v0
    s_mov_b32 s80, 0xffff0000
    s_and_b32 s76, s2, 7
    s_lshr_b32 s77, s2, 3
    s_lshr_b32 s72, s77, 2
    s_lshl_b32 s72, s72, 2
    s_lshr_b32 s73, s76, 1
    s_add_u32 s72, s72, s73
    s_and_b32 s73, s76, 1
    s_lshl_b32 s73, s73, 2
    s_and_b32 s77, s77, 3
    s_add_u32 s73, s73, s77
    s_mov_b32 s78, 0xffff
    s_cmp_eq_u32 s73, 2
    s_cselect_b32 s78, s72, s78
    s_add_u32 s76, s72, 32
    s_cmp_lt_u32 s72, 11
    s_cselect_b32 s76, s76, 0xffff
    s_cmp_eq_u32 s73, 5
    s_cselect_b32 s78, s76, s78
    s_cmp_lt_u32 s72, 11
    s_mov_b32 s76, 4160
    s_cselect_b32 s76, 4224, s76
    s_mul_i32 s77, s76, s73
    s_cmp_gt_u32 s73, 2
    s_cselect_b32 s98, 512, 0
    s_sub_u32 s77, s77, s98
    s_cmp_gt_u32 s73, 5
    s_cselect_b32 s98, 512, 0
    s_cmp_lt_u32 s72, 11
    s_cselect_b32 s98, s98, 0
    s_sub_u32 s77, s77, s98
    s_cmp_eq_u32 s78, 0xffff
    s_cselect_b32 s98, 0, 512
    s_sub_u32 s76, s76, s98
    s_lshr_b32 s74, s76, 2
    s_add_u32 s82, s74, 255
    s_lshr_b32 s82, s82, 8
    s_lshl_b32 s76, s76, 8
    s_lshl_b32 s77, s77, 8
    s_lshl_b32 s98, s72, 23
    s_add_u32 s77, s77, s98
    s_lshl_b32 s83, s3, 10
    s_sub_u32 s99, s82, 1
    s_lshl_b32 s99, s99, 8
    s_sub_u32 s99, s74, s99
    s_sub_i32 s99, s99, s3
    s_add_i32 s99, s99, 15
    s_max_i32 s99, s99, 0
    s_lshr_b32 s99, s99, 4
    s_min_u32 s99, s99, 16
    s_waitcnt lgkmcnt(0)
    s_add_u32 s28, s6, s77
    s_addc_u32 s29, s7, 0
    s_and_b32 s29, s29, 0xffff
    s_mov_b32 s30, s76
    s_mov_b32 s31, 0x00020000
    s_add_u32 s32, s8, s77
    s_addc_u32 s33, s9, 0
    s_and_b32 s33, s33, 0xffff
    s_mov_b32 s34, s76
    s_mov_b32 s35, 0x00020000
    s_mov_b32 s75, s83
    s_mov_b32 s64, s26
    s_and_b32 s65, s27, 0xffff
    s_mov_b32 s66, 4194304
    s_mov_b32 s67, 0x00020000
    s_cmp_ge_u32 s2, 16
    s_cbranch_scc1 L_nozero
    s_mul_i32 s76, s2, 20480
    s_add_u32 s76, s76, s83
    v_mov_b32 v24, 0
    v_mov_b32 v25, 0
    v_mov_b32 v26, 0
    v_mov_b32 v27, 0
    buffer_store_dwordx4 v[24:27], v1, s[64:67], s76 offen sc1
    s_cmp_ge_u32 s3, 4
    s_cbranch_scc1 L_zw
    s_add_u32 s76, s76, 16384
    buffer_store_dwordx4 v[24:27], v1, s[64:67], s76 offen sc1
L_zw:
    s_waitcnt vmcnt(0)
L_nozero:
    s_cmp_ge_u32 s3, 8
    s_cbranch_scc1 L_h0
    buffer_load_dwordx4 v[64:67], v1, s[28:31], s75 offen nt
    s_add_u32 s75, s75, 16384
    buffer_load_dwordx4 v[68:71], v1, s[28:31], s75 offen nt
    s_add_u32 s75, s75, 16384
    buffer_load_dwordx4 v[72:75], v1, s[28:31], s75 offen nt
    s_add_u32 s75, s75, 16384
L_h0:
    s_mov_b32 s36, s10
    s_and_b32 s37, s11, 0xffff
    s_mov_b32 s38, 4194304
    s_mov_b32 s39, 0x00020000
    s_mov_b32 s40, s12
    s_and_b32 s41, s13, 0xffff
    s_mov_b32 s42, 4194304
    s_mov_b32 s43, 0x00020000
    s_mov_b32 s44, s4
    s_and_b32 s45, s5, 0xffff
    s_mov_b32 s46, 1024
    s_mov_b32 s47, 0x00020000
    s_cmp_lt_u32 s3, 8
    s_cselect_b32 s76, s16, s18
    s_cselect_b32 s77, s17, s19
    s_mov_b32 s48, s76
    s_and_b32 s49, s77, 0xffff
    s_cmp_eq_u32 s78, 0xffff
    s_cselect_b32 s50, 0, 1409024
    s_mov_b32 s51, 0x00020000
    s_mov_b32 s52, s20
    s_and_b32 s53, s21, 0xffff
    s_mov_b32 s54, 1409024
    s_mov_b32 s55, 0x00020000
    s_mov_b32 s56, s22
    s_and_b32 s57, s23, 0xffff
    s_mov_b32 s58, 1024
    s_mov_b32 s59, 0x00020000
    s_mov_b32 s60, s24
    s_and_b32 s61, s25, 0xffff
    s_mov_b32 s62, 256
    s_mov_b32 s63, 0x00020000
    s_mov_b32 s4, 0x22222222
    s_mov_b32 s5, 0x22222222
    s_mov_b32 s6, 0x44444444
    s_mov_b32 s7, 0x44444444
    s_mov_b32 s8, 0x88888888
    s_mov_b32 s9, 0x88888888
    s_lshl_b32 s14, s73, 1
    s_add_u32 s14, s14, s3
    s_and_b32 s14, s14, 15
    s_cmp_ge_u32 s3, 8
    s_cbranch_scc1 L_hq
    s_barrier
    s_waitcnt vmcnt(2)
    v_mov_b32 v2, 8448
    buffer_load_dwordx4 v[76:79], v1, s[28:31], s75 offen nt
    s_add_u32 s75, s75, 16384
    ds_read_b32 v3, v2 offset:4
    s_waitcnt vmcnt(2) lgkmcnt(0)
    v_readfirstlane_b32 s76, v3
    s_cmp_lg_u32 s76, 0
    s_cbranch_scc1 L_burst0_4
    buffer_load_dwordx4 v[80:83], v1, s[28:31], s75 offen nt
    s_add_u32 s75, s75, 16384
    ds_read_b32 v3, v2 offset:4
    s_waitcnt vmcnt(2) lgkmcnt(0)
    v_readfirstlane_b32 s76, v3
    s_cmp_lg_u32 s76, 0
    s_cbranch_scc1 L_burst0_5
    buffer_load_dwordx4 v[84:87], v1, s[28:31], s75 offen nt
    s_add_u32 s75, s75, 16384
    ds_read_b32 v3, v2 offset:4
    s_waitcnt vmcnt(2) lgkmcnt(0)
    v_readfirstlane_b32 s76, v3
    s_cmp_lg_u32 s76, 0
    s_cbranch_scc1 L_burst0_6
    buffer_load_dwordx4 v[88:91], v1, s[28:31], s75 offen nt
    s_add_u32 s75, s75, 16384
    ds_read_b32 v3, v2 offset:4
    s_waitcnt vmcnt(2) lgkmcnt(0)
    v_readfirstlane_b32 s76, v3
    s_cmp_lg_u32 s76, 0
    s_cbranch_scc1 L_burst0_7
    buffer_load_dwordx4 v[92:95], v1, s[28:31], s75 offen nt
    s_add_u32 s75, s75, 16384
    ds_read_b32 v3, v2 offset:4
    s_waitcnt vmcnt(2) lgkmcnt(0)
    v_readfirstlane_b32 s76, v3
    s_cmp_lg_u32 s76, 0
    s_cbranch_scc1 L_burst0_8
    buffer_load_dwordx4 v[96:99], v1, s[28:31], s75 offen nt
    s_add_u32 s75, s75, 16384
    ds_read_b32 v3, v2 offset:4
    s_waitcnt vmcnt(2) lgkmcnt(0)
    v_readfirstlane_b32 s76, v3
    s_cmp_lg_u32 s76, 0
    s_cbranch_scc1 L_burst0_9
    buffer_load_dwordx4 v[100:103], v1, s[28:31], s75 offen nt
    s_add_u32 s75, s75, 16384
    ds_read_b32 v3, v2 offset:4
    s_waitcnt vmcnt(2) lgkmcnt(0)
    v_readfirstlane_b32 s76, v3
    s_cmp_lg_u32 s76, 0
    s_cbranch_scc1 L_burst0_10
    buffer_load_dwordx4 v[104:107], v1, s[28:31], s75 offen nt
    s_add_u32 s75, s75, 16384
    ds_read_b32 v3, v2 offset:4
    s_waitcnt vmcnt(2) lgkmcnt(0)
    v_readfirstlane_b32 s76, v3
    s_cmp_lg_u32 s76, 0
    s_cbranch_scc1 L_burst0_11
    buffer_load_dwordx4 v[108:111], v1, s[28:31], s75 offen nt
    s_add_u32 s75, s75, 16384
    ds_read_b32 v3, v2 offset:4
    s_waitcnt vmcnt(2) lgkmcnt(0)
    v_readfirstlane_b32 s76, v3
    s_cmp_lg_u32 s76, 0
    s_cbranch_scc1 L_burst0_12
    buffer_load_dwordx4 v[112:115], v1, s[28:31], s75 offen nt
    s_add_u32 s75, s75, 16384
    ds_read_b32 v3, v2 offset:4
    s_waitcnt vmcnt(2) lgkmcnt(0)
    v_readfirstlane_b32 s76, v3
    s_cmp_lg_u32 s76, 0
    s_cbranch_scc1 L_burst0_13
    buffer_load_dwordx4 v[116:119], v1, s[28:31], s75 offen nt
    s_add_u32 s75, s75, 16384
    ds_read_b32 v3, v2 offset:4
    s_waitcnt vmcnt(2) lgkmcnt(0)
    v_readfirstlane_b32 s76, v3
    s_cmp_lg_u32 s76, 0
    s_cbranch_scc1 L_burst0_14
    buffer_load_dwordx4 v[120:123], v1, s[28:31], s75 offen nt
    s_add_u32 s75, s75, 16384
    ds_read_b32 v3, v2 offset:4
    s_waitcnt vmcnt(2) lgkmcnt(0)
    v_readfirstlane_b32 s76, v3
    s_cmp_lg_u32 s76, 0
    s_cbranch_scc1 L_burst0_15
    buffer_load_dwordx4 v[124:127], v1, s[28:31], s75 offen nt
    s_add_u32 s75, s75, 16384
    s_branch L_qwait0
L_burst0_4:
    buffer_load_dwordx4 v[80:83], v1, s[28:31], s75 offen nt
    s_add_u32 s75, s75, 16384
L_burst0_5:
    buffer_load_dwordx4 v[84:87], v1, s[28:31], s75 offen nt
    s_add_u32 s75, s75, 16384
L_burst0_6:
    buffer_load_dwordx4 v[88:91], v1, s[28:31], s75 offen nt
    s_add_u32 s75, s75, 16384
L_burst0_7:
    buffer_load_dwordx4 v[92:95], v1, s[28:31], s75 offen nt
    s_add_u32 s75, s75, 16384
L_burst0_8:
    buffer_load_dwordx4 v[96:99], v1, s[28:31], s75 offen nt
    s_add_u32 s75, s75, 16384
L_burst0_9:
    buffer_load_dwordx4 v[100:103], v1, s[28:31], s75 offen nt
    s_add_u32 s75, s75, 16384
L_burst0_10:
    buffer_load_dwordx4 v[104:107], v1, s[28:31], s75 offen nt
    s_add_u32 s75, s75, 16384
L_burst0_11:
    buffer_load_dwordx4 v[108:111], v1, s[28:31], s75 offen nt
    s_add_u32 s75, s75, 16384
L_burst0_12:
    buffer_load_dwordx4 v[112:115], v1, s[28:31], s75 offen nt
    s_add_u32 s75, s75, 16384
L_burst0_13:
    buffer_load_dwordx4 v[116:119], v1, s[28:31], s75 offen nt
    s_add_u32 s75, s75, 16384
L_burst0_14:
    buffer_load_dwordx4 v[120:123], v1, s[28:31], s75 offen nt
    s_add_u32 s75, s75, 16384
L_burst0_15:
    buffer_load_dwordx4 v[124:127], v1, s[28:31], s75 offen nt
    s_add_u32 s75, s75, 16384
    s_branch L_qrdy
L_qwait0:
    s_mov_b32 s97, 0
L_qw0:
    ds_read_b32 v3, v2 offset:4
    s_waitcnt lgkmcnt(0)
    v_readfirstlane_b32 s76, v3
    s_add_u32 s97, s97, 1
    s_cmp_gt_u32 s97, 2000000
    s_cbranch_scc1 L_qrdy
    s_cmp_lg_u32 s76, 0
    s_cbranch_scc1 L_qrdy
    s_sleep 2
    s_branch L_qw0
L_hq:
    s_sub_u32 s13, s3, 8
    buffer_load_dwordx4 v[24:27], v1, s[44:47], 0 offen
    v_lshrrev_b32 v2, 4, v0
    s_lshl_b32 s76, s73, 6
    s_lshl_b32 s77, s13, 3
    s_add_u32 s76, s76, s77
    v_lshlrev_b32 v3, 1, v2
    s_lshl_b32 s77, s76, 1
    buffer_load_ushort v13, v3, s[44:47], s77 offen
    buffer_load_ushort v14, v3, s[44:47], s77 offen offset:8
    v_lshlrev_b32 v3, 13, v2
    v_and_b32 v15, 15, v0
    v_lshl_add_u32 v3, v15, 4, v3
    s_lshl_b32 s76, s76, 13
    s_lshl_b32 s77, s72, 8
    s_add_u32 s76, s76, s77
    buffer_load_dwordx4 v[32:35], v3, s[36:39], s76 offen nt
    s_add_u32 s76, s76, 32768
    buffer_load_dwordx4 v[36:39], v3, s[36:39], s76 offen nt
    s_cmp_lg_u32 s3, 8
    s_cbranch_scc1 L_svc0
    v_mov_b32 v2, 8448
    v_mov_b32 v16, 0
    v_mov_b32 v17, 0
    v_mov_b32 v18, 0
    v_mov_b32 v19, 0
    ds_write_b128 v2, v[16:19]
    ds_write_b128 v1, v[16:19] offset:8704
    ds_write_b128 v1, v[16:19] offset:9728
    s_waitcnt lgkmcnt(0)
L_svc0:
    s_barrier
    s_cmp_ge_u32 s2, 16
    s_cbranch_scc1 L_noflag
    s_cmp_lg_u32 s3, 8
    s_cbranch_scc1 L_noflag
    v_mov_b32 v2, 1
    s_mov_b64 exec, 1
    buffer_atomic_add v2, off, s[60:63], 0
    s_mov_b64 exec, -1
L_noflag:
    s_waitcnt vmcnt(0)
    v_lshlrev_b32 v16, 16, v24
    v_and_b32 v17, s80, v24
    v_lshlrev_b32 v18, 16, v25
    v_and_b32 v19, s80, v25
    v_lshlrev_b32 v20, 16, v26
    v_and_b32 v21, s80, v26
    v_lshlrev_b32 v22, 16, v27
    v_and_b32 v23, s80, v27
    v_add_f32 v2, v16, v17
    v_add_f32 v2, v2, v18
    v_add_f32 v2, v2, v19
    v_add_f32 v2, v2, v20
    v_add_f32 v2, v2, v21
    v_add_f32 v2, v2, v22
    v_add_f32 v2, v2, v23
    s_nop 1
    v_add_f32_dpp v2, v2, v2 row_ror:8 row_mask:0xf bank_mask:0xf
    s_nop 1
    v_add_f32_dpp v2, v2, v2 row_ror:4 row_mask:0xf bank_mask:0xf
    s_nop 1
    v_add_f32_dpp v2, v2, v2 row_ror:2 row_mask:0xf bank_mask:0xf
    s_nop 1
    v_add_f32_dpp v2, v2, v2 row_ror:1 row_mask:0xf bank_mask:0xf
    v_mov_b32 v3, v2
    s_nop 1
    v_permlane16_swap_b32 v2, v3
    s_nop 0
    v_add_f32 v2, v2, v3
    v_mov_b32 v3, v2
    s_nop 1
    v_permlane32_swap_b32 v2, v3
    s_nop 0
    v_add_f32 v2, v2, v3
    v_mul_f32 v2, 0x3b000000, v2
    v_sub_f32 v24, v16, v2
    v_sub_f32 v25, v17, v2
    v_sub_f32 v26, v18, v2
    v_sub_f32 v27, v19, v2
    v_sub_f32 v28, v20, v2
    v_sub_f32 v29, v21, v2
    v_sub_f32 v30, v22, v2
    v_sub_f32 v31, v23, v2
    v_mul_f32 v15, v24, v24
    v_fmac_f32 v15, v25, v25
    v_fmac_f32 v15, v26, v26
    v_fmac_f32 v15, v27, v27
    v_fmac_f32 v15, v28, v28
    v_fmac_f32 v15, v29, v29
    v_fmac_f32 v15, v30, v30
    v_fmac_f32 v15, v31, v31
    s_nop 1
    v_add_f32_dpp v15, v15, v15 row_ror:8 row_mask:0xf bank_mask:0xf
    s_nop 1
    v_add_f32_dpp v15, v15, v15 row_ror:4 row_mask:0xf bank_mask:0xf
    s_nop 1
    v_add_f32_dpp v15, v15, v15 row_ror:2 row_mask:0xf bank_mask:0xf
    s_nop 1
    v_add_f32_dpp v15, v15, v15 row_ror:1 row_mask:0xf bank_mask:0xf
    v_mov_b32 v3, v15
    s_nop 1
    v_permlane16_swap_b32 v15, v3
    s_nop 0
    v_add_f32 v15, v15, v3
    v_mov_b32 v3, v15
    s_nop 1
    v_permlane32_swap_b32 v15, v3
    s_nop 0
    v_add_f32 v15, v15, v3
    v_mul_f32 v15, 0x3b000000, v15
    v_cvt_pk_bf16_f32 v2, v2, v2
    v_lshlrev_b32 v2, 16, v2
    v_cvt_pk_bf16_f32 v15, v15, v15
    v_lshlrev_b32 v15, 16, v15
    v_add_f32 v15, 0x3727c5ac, v15
    v_cvt_pk_bf16_f32 v15, v15, v15
    v_lshlrev_b32 v15, 16, v15
    v_sqrt_f32 v15, v15
    s_nop 0
    v_cvt_pk_bf16_f32 v15, v15, v15
    v_lshlrev_b32 v15, 16, v15
    v_rcp_f32 v3, v15
    s_nop 0
    v_readfirstlane_b32 s10, v2
    v_readfirstlane_b32 s11, v15
    v_readfirstlane_b32 s12, v3
    s_nop 1
    v_lshlrev_b32 v13, 16, v13
    v_lshlrev_b32 v14, 16, v14
    v_subrev_f32 v13, s10, v13
    v_cvt_pk_bf16_f32 v13, v13, v13
    v_lshlrev_b32 v13, 16, v13
    v_mul_f32 v3, s12, v13
    v_fma_f32 v13, -v3, s11, v13
    v_fma_f32 v13, v13, s12, v3
    v_cvt_pk_bf16_f32 v13, v13, v13
    v_lshlrev_b32 v13, 16, v13
    v_subrev_f32 v14, s10, v14
    v_cvt_pk_bf16_f32 v14, v14, v14
    v_lshlrev_b32 v14, 16, v14
    v_mul_f32 v3, s12, v14
    v_fma_f32 v14, -v3, s11, v14
    v_fma_f32 v14, v14, s12, v3
    v_cvt_pk_bf16_f32 v14, v14, v14
    v_lshlrev_b32 v14, 16, v14
    v_lshlrev_b32 v24, 16, v32
    v_and_b32 v25, s80, v32
    v_lshlrev_b32 v26, 16, v36
    v_and_b32 v27, s80, v36
    v_mul_f32 v4, v13, v24
    v_mul_f32 v5, v13, v25
    v_fmac_f32 v4, v14, v26
    v_fmac_f32 v5, v14, v27
    v_lshlrev_b32 v24, 16, v33
    v_and_b32 v25, s80, v33
    v_lshlrev_b32 v26, 16, v37
    v_and_b32 v27, s80, v37
    v_mul_f32 v6, v13, v24
    v_mul_f32 v7, v13, v25
    v_fmac_f32 v6, v14, v26
    v_fmac_f32 v7, v14, v27
    v_lshlrev_b32 v24, 16, v34
    v_and_b32 v25, s80, v34
    v_lshlrev_b32 v26, 16, v38
    v_and_b32 v27, s80, v38
    v_mul_f32 v8, v13, v24
    v_mul_f32 v9, v13, v25
    v_fmac_f32 v8, v14, v26
    v_fmac_f32 v9, v14, v27
    v_lshlrev_b32 v24, 16, v35
    v_and_b32 v25, s80, v35
    v_lshlrev_b32 v26, 16, v39
    v_and_b32 v27, s80, v39
    v_mul_f32 v10, v13, v24
    v_mul_f32 v11, v13, v25
    v_fmac_f32 v10, v14, v26
    v_fmac_f32 v11, v14, v27
    s_nop 1
    v_permlane32_swap_b32 v4, v8
    v_permlane32_swap_b32 v5, v9
    v_permlane32_swap_b32 v6, v10
    v_permlane32_swap_b32 v7, v11
    s_nop 0
    v_add_f32 v4, v4, v8
    v_add_f32 v5, v5, v9
    v_add_f32 v6, v6, v10
    v_add_f32 v7, v7, v11
    s_nop 1
    v_permlane16_swap_b32 v4, v6
    v_permlane16_swap_b32 v5, v7
    s_nop 0
    v_add_f32 v4, v4, v6
    v_add_f32 v5, v5, v7
    v_and_b32 v2, 15, v0
    v_lshlrev_b32 v2, 5, v2
    v_lshrrev_b32 v3, 4, v0
    v_lshl_add_u32 v15, v3, 3, v2
    s_lshl_b32 s76, s13, 9
    v_add_u32 v2, s76, v15
    ds_write_b64 v2, v[4:5] offset:0
    s_waitcnt lgkmcnt(0)
    v_mov_b32 v2, 8448
    v_mov_b32 v3, 1
    s_mov_b64 exec, 1
    ds_add_u32 v2, v3
    s_mov_b64 exec, -1
    s_cmp_eq_u32 s3, 8
    s_cbranch_scc1 L_svc1
    v_mov_b32 v2, 8448
    buffer_load_dwordx4 v[64:67], v1, s[28:31], s75 offen nt
    s_add_u32 s75, s75, 16384
    buffer_load_dwordx4 v[68:71], v1, s[28:31], s75 offen nt
    s_add_u32 s75, s75, 16384
    buffer_load_dwordx4 v[72:75], v1, s[28:31], s75 offen nt
    s_add_u32 s75, s75, 16384
    ds_read_b32 v3, v2 offset:4
    s_waitcnt vmcnt(2) lgkmcnt(0)
    v_readfirstlane_b32 s76, v3
    s_cmp_lg_u32 s76, 0
    s_cbranch_scc1 L_burst1_3
    buffer_load_dwordx4 v[76:79], v1, s[28:31], s75 offen nt
    s_add_u32 s75, s75, 16384
    ds_read_b32 v3, v2 offset:4
    s_waitcnt vmcnt(2) lgkmcnt(0)
    v_readfirstlane_b32 s76, v3
    s_cmp_lg_u32 s76, 0
    s_cbranch_scc1 L_burst1_4
    buffer_load_dwordx4 v[80:83], v1, s[28:31], s75 offen nt
    s_add_u32 s75, s75, 16384
    ds_read_b32 v3, v2 offset:4
    s_waitcnt vmcnt(2) lgkmcnt(0)
    v_readfirstlane_b32 s76, v3
    s_cmp_lg_u32 s76, 0
    s_cbranch_scc1 L_burst1_5
    buffer_load_dwordx4 v[84:87], v1, s[28:31], s75 offen nt
    s_add_u32 s75, s75, 16384
    ds_read_b32 v3, v2 offset:4
    s_waitcnt vmcnt(2) lgkmcnt(0)
    v_readfirstlane_b32 s76, v3
    s_cmp_lg_u32 s76, 0
    s_cbranch_scc1 L_burst1_6
    buffer_load_dwordx4 v[88:91], v1, s[28:31], s75 offen nt
    s_add_u32 s75, s75, 16384
    ds_read_b32 v3, v2 offset:4
    s_waitcnt vmcnt(2) lgkmcnt(0)
    v_readfirstlane_b32 s76, v3
    s_cmp_lg_u32 s76, 0
    s_cbranch_scc1 L_burst1_7
    buffer_load_dwordx4 v[92:95], v1, s[28:31], s75 offen nt
    s_add_u32 s75, s75, 16384
    ds_read_b32 v3, v2 offset:4
    s_waitcnt vmcnt(2) lgkmcnt(0)
    v_readfirstlane_b32 s76, v3
    s_cmp_lg_u32 s76, 0
    s_cbranch_scc1 L_burst1_8
    buffer_load_dwordx4 v[96:99], v1, s[28:31], s75 offen nt
    s_add_u32 s75, s75, 16384
    ds_read_b32 v3, v2 offset:4
    s_waitcnt vmcnt(2) lgkmcnt(0)
    v_readfirstlane_b32 s76, v3
    s_cmp_lg_u32 s76, 0
    s_cbranch_scc1 L_burst1_9
    buffer_load_dwordx4 v[100:103], v1, s[28:31], s75 offen nt
    s_add_u32 s75, s75, 16384
    ds_read_b32 v3, v2 offset:4
    s_waitcnt vmcnt(2) lgkmcnt(0)
    v_readfirstlane_b32 s76, v3
    s_cmp_lg_u32 s76, 0
    s_cbranch_scc1 L_burst1_10
    buffer_load_dwordx4 v[104:107], v1, s[28:31], s75 offen nt
    s_add_u32 s75, s75, 16384
    ds_read_b32 v3, v2 offset:4
    s_waitcnt vmcnt(2) lgkmcnt(0)
    v_readfirstlane_b32 s76, v3
    s_cmp_lg_u32 s76, 0
    s_cbranch_scc1 L_burst1_11
    buffer_load_dwordx4 v[108:111], v1, s[28:31], s75 offen nt
    s_add_u32 s75, s75, 16384
    ds_read_b32 v3, v2 offset:4
    s_waitcnt vmcnt(2) lgkmcnt(0)
    v_readfirstlane_b32 s76, v3
    s_cmp_lg_u32 s76, 0
    s_cbranch_scc1 L_burst1_12
    buffer_load_dwordx4 v[112:115], v1, s[28:31], s75 offen nt
    s_add_u32 s75, s75, 16384
    ds_read_b32 v3, v2 offset:4
    s_waitcnt vmcnt(2) lgkmcnt(0)
    v_readfirstlane_b32 s76, v3
    s_cmp_lg_u32 s76, 0
    s_cbranch_scc1 L_burst1_13
    buffer_load_dwordx4 v[116:119], v1, s[28:31], s75 offen nt
    s_add_u32 s75, s75, 16384
    ds_read_b32 v3, v2 offset:4
    s_waitcnt vmcnt(2) lgkmcnt(0)
    v_readfirstlane_b32 s76, v3
    s_cmp_lg_u32 s76, 0
    s_cbranch_scc1 L_burst1_14
    buffer_load_dwordx4 v[120:123], v1, s[28:31], s75 offen nt
    s_add_u32 s75, s75, 16384
    ds_read_b32 v3, v2 offset:4
    s_waitcnt vmcnt(2) lgkmcnt(0)
    v_readfirstlane_b32 s76, v3
    s_cmp_lg_u32 s76, 0
    s_cbranch_scc1 L_burst1_15
    buffer_load_dwordx4 v[124:127], v1, s[28:31], s75 offen nt
    s_add_u32 s75, s75, 16384
    s_branch L_qwait1
L_burst1_3:
    buffer_load_dwordx4 v[76:79], v1, s[28:31], s75 offen nt
    s_add_u32 s75, s75, 16384
L_burst1_4:
    buffer_load_dwordx4 v[80:83], v1, s[28:31], s75 offen nt
    s_add_u32 s75, s75, 16384
L_burst1_5:
    buffer_load_dwordx4 v[84:87], v1, s[28:31], s75 offen nt
    s_add_u32 s75, s75, 16384
L_burst1_6:
    buffer_load_dwordx4 v[88:91], v1, s[28:31], s75 offen nt
    s_add_u32 s75, s75, 16384
L_burst1_7:
    buffer_load_dwordx4 v[92:95], v1, s[28:31], s75 offen nt
    s_add_u32 s75, s75, 16384
L_burst1_8:
    buffer_load_dwordx4 v[96:99], v1, s[28:31], s75 offen nt
    s_add_u32 s75, s75, 16384
L_burst1_9:
    buffer_load_dwordx4 v[100:103], v1, s[28:31], s75 offen nt
    s_add_u32 s75, s75, 16384
L_burst1_10:
    buffer_load_dwordx4 v[104:107], v1, s[28:31], s75 offen nt
    s_add_u32 s75, s75, 16384
L_burst1_11:
    buffer_load_dwordx4 v[108:111], v1, s[28:31], s75 offen nt
    s_add_u32 s75, s75, 16384
L_burst1_12:
    buffer_load_dwordx4 v[112:115], v1, s[28:31], s75 offen nt
    s_add_u32 s75, s75, 16384
L_burst1_13:
    buffer_load_dwordx4 v[116:119], v1, s[28:31], s75 offen nt
    s_add_u32 s75, s75, 16384
L_burst1_14:
    buffer_load_dwordx4 v[120:123], v1, s[28:31], s75 offen nt
    s_add_u32 s75, s75, 16384
L_burst1_15:
    buffer_load_dwordx4 v[124:127], v1, s[28:31], s75 offen nt
    s_add_u32 s75, s75, 16384
    s_branch L_qrdy
L_qwait1:
    s_mov_b32 s97, 0
L_qw1:
    ds_read_b32 v3, v2 offset:4
    s_waitcnt lgkmcnt(0)
    v_readfirstlane_b32 s76, v3
    s_add_u32 s97, s97, 1
    s_cmp_gt_u32 s97, 2000000
    s_cbranch_scc1 L_qrdy
    s_cmp_lg_u32 s76, 0
    s_cbranch_scc1 L_qrdy
    s_sleep 2
    s_branch L_qw1
L_svc1:
    s_mov_b32 s97, 0
L_lpoll:
    ds_read_b32 v3, v2
    s_waitcnt lgkmcnt(0)
    v_readfirstlane_b32 s76, v3
    s_add_u32 s97, s97, 1
    s_cmp_gt_u32 s97, 1000000
    s_cbranch_scc1 L_lok
    s_cmp_lt_u32 s76, 8
    s_cbranch_scc1 L_lpoll
L_lok:
    ds_read_b64 v[24:25], v15 offset:0
    ds_read_b64 v[26:27], v15 offset:512
    ds_read_b64 v[28:29], v15 offset:1024
    ds_read_b64 v[30:31], v15 offset:1536
    s_waitcnt lgkmcnt(0)
    v_add_f32 v4, v24, v26
    v_add_f32 v5, v25, v27
    v_add_f32 v4, v4, v28
    v_add_f32 v5, v5, v29
    v_add_f32 v4, v4, v30
    v_add_f32 v5, v5, v31
    ds_read_b64 v[24:25], v15 offset:2048
    ds_read_b64 v[26:27], v15 offset:2560
    ds_read_b64 v[28:29], v15 offset:3072
    ds_read_b64 v[30:31], v15 offset:3584
    s_waitcnt lgkmcnt(0)
    v_add_f32 v4, v4, v24
    v_add_f32 v5, v5, v25
    v_add_f32 v4, v4, v26
    v_add_f32 v5, v5, v27
    v_add_f32 v4, v4, v28
    v_add_f32 v5, v5, v29
    v_add_f32 v4, v4, v30
    v_add_f32 v5, v5, v31
    v_not_b32 v4, v4
    v_not_b32 v5, v5
    buffer_load_dword v13, off, s[60:63], 0 sc1
    s_cmp_eq_u32 s78, 0xffff
    s_cbranch_scc1 L_noxn
    v_subrev_f32 v16, s10, v16
    v_cvt_pk_bf16_f32 v16, v16, v16
    v_lshlrev_b32 v16, 16, v16
    v_mul_f32 v3, s12, v16
    v_fma_f32 v16, -v3, s11, v16
    v_fma_f32 v16, v16, s12, v3
    v_cvt_pk_bf16_f32 v16, v16, v16
    v_lshlrev_b32 v16, 16, v16
    v_subrev_f32 v17, s10, v17
    v_cvt_pk_bf16_f32 v17, v17, v17
    v_lshlrev_b32 v17, 16, v17
    v_mul_f32 v3, s12, v17
    v_fma_f32 v17, -v3, s11, v17
    v_fma_f32 v17, v17, s12, v3
    v_cvt_pk_bf16_f32 v17, v17, v17
    v_lshlrev_b32 v17, 16, v17
    v_subrev_f32 v18, s10, v18
    v_cvt_pk_bf16_f32 v18, v18, v18
    v_lshlrev_b32 v18, 16, v18
    v_mul_f32 v3, s12, v18
    v_fma_f32 v18, -v3, s11, v18
    v_fma_f32 v18, v18, s12, v3
    v_cvt_pk_bf16_f32 v18, v18, v18
    v_lshlrev_b32 v18, 16, v18
    v_subrev_f32 v19, s10, v19
    v_cvt_pk_bf16_f32 v19, v19, v19
    v_lshlrev_b32 v19, 16, v19
    v_mul_f32 v3, s12, v19
    v_fma_f32 v19, -v3, s11, v19
    v_fma_f32 v19, v19, s12, v3
    v_cvt_pk_bf16_f32 v19, v19, v19
    v_lshlrev_b32 v19, 16, v19
    v_subrev_f32 v20, s10, v20
    v_cvt_pk_bf16_f32 v20, v20, v20
    v_lshlrev_b32 v20, 16, v20
    v_mul_f32 v3, s12, v20
    v_fma_f32 v20, -v3, s11, v20
    v_fma_f32 v20, v20, s12, v3
    v_cvt_pk_bf16_f32 v20, v20, v20
    v_lshlrev_b32 v20, 16, v20
    v_subrev_f32 v21, s10, v21
    v_cvt_pk_bf16_f32 v21, v21, v21
    v_lshlrev_b32 v21, 16, v21
    v_mul_f32 v3, s12, v21
    v_fma_f32 v21, -v3, s11, v21
    v_fma_f32 v21, v21, s12, v3
    v_cvt_pk_bf16_f32 v21, v21, v21
    v_lshlrev_b32 v21, 16, v21
    v_subrev_f32 v22, s10, v22
    v_cvt_pk_bf16_f32 v22, v22, v22
    v_lshlrev_b32 v22, 16, v22
    v_mul_f32 v3, s12, v22
    v_fma_f32 v22, -v3, s11, v22
    v_fma_f32 v22, v22, s12, v3
    v_cvt_pk_bf16_f32 v22, v22, v22
    v_lshlrev_b32 v22, 16, v22
    v_subrev_f32 v23, s10, v23
    v_cvt_pk_bf16_f32 v23, v23, v23
    v_lshlrev_b32 v23, 16, v23
    v_mul_f32 v3, s12, v23
    v_fma_f32 v23, -v3, s11, v23
    v_fma_f32 v23, v23, s12, v3
    v_cvt_pk_bf16_f32 v23, v23, v23
    v_lshlrev_b32 v23, 16, v23
    v_lshlrev_b32 v3, 5, v0
    ds_write_b128 v3, v[16:19] offset:4352
    ds_write_b128 v3, v[20:23] offset:4368
L_noxn:
    s_mov_b32 s97, 0
L_zpoll:
    s_waitcnt vmcnt(0)
    v_readfirstlane_b32 s76, v13
    s_add_u32 s97, s97, 1
    s_cmp_gt_u32 s97, 20000
    s_cbranch_scc1 L_zok
    s_cmp_ge_u32 s76, 16
    s_cbranch_scc1 L_zok
    s_sleep 8
    buffer_load_dword v13, off, s[60:63], 0 sc1
    s_branch L_zpoll
L_zok:
    s_lshl_b32 s76, s72, 3
    s_add_u32 s76, s76, s73
    s_lshl_b32 s76, s76, 9
    s_add_u32 s76, s76, 53248
    buffer_store_dwordx2 v[4:5], v15, s[64:67], s76 offen sc1
    s_lshl_b32 s76, s72, 12
    s_add_u32 s76, s76, 53248
    s_mov_b32 s97, 0
L_qpoll:
    buffer_load_dwordx2 v[32:33], v15, s[64:67], s76 offen offset:0 sc1
    buffer_load_dwordx2 v[34:35], v15, s[64:67], s76 offen offset:512 sc1
    buffer_load_dwordx2 v[36:37], v15, s[64:67], s76 offen offset:1024 sc1
    buffer_load_dwordx2 v[38:39], v15, s[64:67], s76 offen offset:1536 sc1
    buffer_load_dwordx2 v[40:41], v15, s[64:67], s76 offen offset:2048 sc1
    buffer_load_dwordx2 v[42:43], v15, s[64:67], s76 offen offset:2560 sc1
    buffer_load_dwordx2 v[44:45], v15, s[64:67], s76 offen offset:3072 sc1
    buffer_load_dwordx2 v[46:47], v15, s[64:67], s76 offen offset:3584 sc1
    s_waitcnt vmcnt(0)
    v_min_u32 v2, v32, v33
    v_min_u32 v2, v2, v34
    v_min_u32 v2, v2, v35
    v_min_u32 v2, v2, v36
    v_min_u32 v2, v2, v37
    v_min_u32 v2, v2, v38
    v_min_u32 v2, v2, v39
    v_min_u32 v2, v2, v40
    v_min_u32 v2, v2, v41
    v_min_u32 v2, v2, v42
    v_min_u32 v2, v2, v43
    v_min_u32 v2, v2, v44
    v_min_u32 v2, v2, v45
    v_min_u32 v2, v2, v46
    v_min_u32 v2, v2, v47
    s_add_u32 s97, s97, 1
    s_cmp_gt_u32 s97, 20000
    s_cbranch_scc1 L_qok
    v_cmp_eq_u32 vcc, 0, v2
    s_cbranch_vccz L_qok
    s_sleep 8
    s_branch L_qpoll
L_qok:
    v_not_b32 v32, v32
    v_not_b32 v33, v33
    v_not_b32 v34, v34
    v_not_b32 v35, v35
    v_not_b32 v36, v36
    v_not_b32 v37, v37
    v_not_b32 v38, v38
    v_not_b32 v39, v39
    v_not_b32 v40, v40
    v_not_b32 v41, v41
    v_not_b32 v42, v42
    v_not_b32 v43, v43
    v_not_b32 v44, v44
    v_not_b32 v45, v45
    v_not_b32 v46, v46
    v_not_b32 v47, v47
    v_add_f32 v4, v32, v34
    v_add_f32 v5, v33, v35
    v_add_f32 v4, v4, v36
    v_add_f32 v5, v5, v37
    v_add_f32 v4, v4, v38
    v_add_f32 v5, v5, v39
    v_add_f32 v4, v4, v40
    v_add_f32 v5, v5, v41
    v_add_f32 v4, v4, v42
    v_add_f32 v5, v5, v43
    v_add_f32 v4, v4, v44
    v_add_f32 v5, v5, v45
    v_add_f32 v4, v4, v46
    v_add_f32 v5, v5, v47
    v_cvt_pk_bf16_f32 v4, v4, v5
    v_lshrrev_b32 v2, 1, v15
    ds_write_b32 v2, v4 offset:4096
    s_waitcnt lgkmcnt(0)
    v_mov_b32 v2, 8448
    v_mov_b32 v3, 1
    ds_write_b32 v2, v3 offset:4
    buffer_load_dwordx4 v[64:67], v1, s[28:31], s75 offen nt
    s_add_u32 s75, s75, 16384
    buffer_load_dwordx4 v[68:71], v1, s[28:31], s75 offen nt
    s_add_u32 s75, s75, 16384
    buffer_load_dwordx4 v[72:75], v1, s[28:31], s75 offen nt
    s_add_u32 s75, s75, 16384
    buffer_load_dwordx4 v[76:79], v1, s[28:31], s75 offen nt
    s_add_u32 s75, s75, 16384
    buffer_load_dwordx4 v[80:83], v1, s[28:31], s75 offen nt
    s_add_u32 s75, s75, 16384
    buffer_load_dwordx4 v[84:87], v1, s[28:31], s75 offen nt
    s_add_u32 s75, s75, 16384
    buffer_load_dwordx4 v[88:91], v1, s[28:31], s75 offen nt
    s_add_u32 s75, s75, 16384
    buffer_load_dwordx4 v[92:95], v1, s[28:31], s75 offen nt
    s_add_u32 s75, s75, 16384
    buffer_load_dwordx4 v[96:99], v1, s[28:31], s75 offen nt
    s_add_u32 s75, s75, 16384
    buffer_load_dwordx4 v[100:103], v1, s[28:31], s75 offen nt
    s_add_u32 s75, s75, 16384
    buffer_load_dwordx4 v[104:107], v1, s[28:31], s75 offen nt
    s_add_u32 s75, s75, 16384
    buffer_load_dwordx4 v[108:111], v1, s[28:31], s75 offen nt
    s_add_u32 s75, s75, 16384
    buffer_load_dwordx4 v[112:115], v1, s[28:31], s75 offen nt
    s_add_u32 s75, s75, 16384
    buffer_load_dwordx4 v[116:119], v1, s[28:31], s75 offen nt
    s_add_u32 s75, s75, 16384
    buffer_load_dwordx4 v[120:123], v1, s[28:31], s75 offen nt
    s_add_u32 s75, s75, 16384
    buffer_load_dwordx4 v[124:127], v1, s[28:31], s75 offen nt
    s_add_u32 s75, s75, 16384
L_qrdy:
    v_and_b32 v2, 15, v0
    v_lshlrev_b32 v2, 4, v2
    ds_read_b128 v[4:7], v2 offset:4096
    s_waitcnt lgkmcnt(0)
    s_and_b32 s76, s3, 7
    s_lshl_b32 s76, s76, 6
    v_lshrrev_b32 v2, 2, v0
    v_add_u32 v2, s76, v2
    s_movk_i32 s76, 2752
    v_mul_lo_u32 v3, v2, s76
    v_and_b32 v2, 3, v0
    v_lshl_add_u32 v3, v2, 4, v3
    s_and_b32 s76, s78, 63
    s_lshl_b32 s76, s76, 6
    buffer_load_dwordx4 v[48:51], v3, s[48:51], s76 offen nt
    s_add_u32 s76, s76, 44032
    buffer_load_dwordx4 v[52:55], v3, s[48:51], s76 offen nt
    s_add_u32 s76, s76, 44032
    buffer_load_dwordx4 v[56:59], v3, s[48:51], s76 offen nt
    s_add_u32 s76, s76, 44032
    buffer_load_dwordx4 v[60:63], v3, s[48:51], s76 offen nt
    s_mov_b32 s68, s28
    s_mov_b32 s69, s29
    s_mov_b32 s70, s30
    s_mov_b32 s71, s31
    s_waitcnt vmcnt(19)
    v_dot2_f32_bf16 v32, v64, v4, 0
    v_dot2c_f32_bf16 v32, v65, v5
    v_dot2c_f32_bf16 v32, v66, v6
    v_dot2c_f32_bf16 v32, v67, v7
    buffer_load_dwordx4 v[64:67], v1, s[68:71], s75 offen nt
    s_add_u32 s75, s75, 16384
    s_waitcnt vmcnt(19)
    v_dot2_f32_bf16 v33, v68, v4, 0
    v_dot2c_f32_bf16 v33, v69, v5
    v_dot2c_f32_bf16 v33, v70, v6
    v_dot2c_f32_bf16 v33, v71, v7
    buffer_load_dwordx4 v[68:71], v1, s[68:71], s75 offen nt
    s_add_u32 s75, s75, 16384
    s_waitcnt vmcnt(19)
    v_dot2_f32_bf16 v34, v72, v4, 0
    v_dot2c_f32_bf16 v34, v73, v5
    v_dot2c_f32_bf16 v34, v74, v6
    v_dot2c_f32_bf16 v34, v75, v7
    s_waitcnt vmcnt(18)
    v_dot2_f32_bf16 v35, v76, v4, 0
    v_dot2c_f32_bf16 v35, v77, v5
    v_dot2c_f32_bf16 v35, v78, v6
    v_dot2c_f32_bf16 v35, v79, v7
    s_waitcnt vmcnt(17)
    v_dot2_f32_bf16 v36, v80, v4, 0
    v_dot2c_f32_bf16 v36, v81, v5
    v_dot2c_f32_bf16 v36, v82, v6
    v_dot2c_f32_bf16 v36, v83, v7
    s_waitcnt vmcnt(16)
    v_dot2_f32_bf16 v37, v84, v4, 0
    v_dot2c_f32_bf16 v37, v85, v5
    v_dot2c_f32_bf16 v37, v86, v6
    v_dot2c_f32_bf16 v37, v87, v7
    s_waitcnt vmcnt(15)
    v_dot2_f32_bf16 v38, v88, v4, 0
    v_dot2c_f32_bf16 v38, v89, v5
    v_dot2c_f32_bf16 v38, v90, v6
    v_dot2c_f32_bf16 v38, v91, v7
    s_waitcnt vmcnt(14)
    v_dot2_f32_bf16 v39, v92, v4, 0
    v_dot2c_f32_bf16 v39, v93, v5
    v_dot2c_f32_bf16 v39, v94, v6
    v_dot2c_f32_bf16 v39, v95, v7
    s_waitcnt vmcnt(13)
    v_dot2_f32_bf16 v40, v96, v4, 0
    v_dot2c_f32_bf16 v40, v97, v5
    v_dot2c_f32_bf16 v40, v98, v6
    v_dot2c_f32_bf16 v40, v99, v7
    s_waitcnt vmcnt(12)
    v_dot2_f32_bf16 v41, v100, v4, 0
    v_dot2c_f32_bf16 v41, v101, v5
    v_dot2c_f32_bf16 v41, v102, v6
    v_dot2c_f32_bf16 v41, v103, v7
    s_waitcnt vmcnt(11)
    v_dot2_f32_bf16 v42, v104, v4, 0
    v_dot2c_f32_bf16 v42, v105, v5
    v_dot2c_f32_bf16 v42, v106, v6
    v_dot2c_f32_bf16 v42, v107, v7
    s_waitcnt vmcnt(10)
    v_dot2_f32_bf16 v43, v108, v4, 0
    v_dot2c_f32_bf16 v43, v109, v5
    v_dot2c_f32_bf16 v43, v110, v6
    v_dot2c_f32_bf16 v43, v111, v7
    s_waitcnt vmcnt(9)
    v_dot2_f32_bf16 v44, v112, v4, 0
    v_dot2c_f32_bf16 v44, v113, v5
    v_dot2c_f32_bf16 v44, v114, v6
    v_dot2c_f32_bf16 v44, v115, v7
    s_waitcnt vmcnt(8)
    v_dot2_f32_bf16 v45, v116, v4, 0
    v_dot2c_f32_bf16 v45, v117, v5
    v_dot2c_f32_bf16 v45, v118, v6
    v_dot2c_f32_bf16 v45, v119, v7
    s_waitcnt vmcnt(7)
    v_dot2_f32_bf16 v46, v120, v4, 0
    v_dot2c_f32_bf16 v46, v121, v5
    v_dot2c_f32_bf16 v46, v122, v6
    v_dot2c_f32_bf16 v46, v123, v7
    s_waitcnt vmcnt(6)
    v_dot2_f32_bf16 v47, v124, v4, 0
    v_dot2c_f32_bf16 v47, v125, v5
    v_dot2c_f32_bf16 v47, v126, v6
    v_dot2c_f32_bf16 v47, v127, v7
    s_nop 1
    v_add_f32_dpp v32, v32, v32 row_ror:8 row_mask:0xf bank_mask:0x3
    v_add_f32_dpp v33, v33, v33 row_ror:8 row_mask:0xf bank_mask:0x3
    v_add_f32_dpp v34, v34, v34 row_ror:8 row_mask:0xf bank_mask:0x3
    v_add_f32_dpp v35, v35, v35 row_ror:8 row_mask:0xf bank_mask:0x3
    v_add_f32_dpp v36, v36, v36 row_ror:8 row_mask:0xf bank_mask:0x3
    v_add_f32_dpp v37, v37, v37 row_ror:8 row_mask:0xf bank_mask:0x3
    v_add_f32_dpp v38, v38, v38 row_ror:8 row_mask:0xf bank_mask:0x3
    v_add_f32_dpp v39, v39, v39 row_ror:8 row_mask:0xf bank_mask:0x3
    v_add_f32_dpp v32, v40, v40 row_ror:8 row_mask:0xf bank_mask:0xc
    v_add_f32_dpp v33, v41, v41 row_ror:8 row_mask:0xf bank_mask:0xc
    v_add_f32_dpp v34, v42, v42 row_ror:8 row_mask:0xf bank_mask:0xc
    v_add_f32_dpp v35, v43, v43 row_ror:8 row_mask:0xf bank_mask:0xc
    v_add_f32_dpp v36, v44, v44 row_ror:8 row_mask:0xf bank_mask:0xc
    v_add_f32_dpp v37, v45, v45 row_ror:8 row_mask:0xf bank_mask:0xc
    v_add_f32_dpp v38, v46, v46 row_ror:8 row_mask:0xf bank_mask:0xc
    v_add_f32_dpp v39, v47, v47 row_ror:8 row_mask:0xf bank_mask:0xc
    s_nop 1
    v_add_f32_dpp v32, v32, v32 row_shl:4 row_mask:0xf bank_mask:0x5
    v_add_f32_dpp v33, v33, v33 row_shl:4 row_mask:0xf bank_mask:0x5
    v_add_f32_dpp v34, v34, v34 row_shl:4 row_mask:0xf bank_mask:0x5
    v_add_f32_dpp v35, v35, v35 row_shl:4 row_mask:0xf bank_mask:0x5
    v_add_f32_dpp v32, v36, v36 row_shr:4 row_mask:0xf bank_mask:0xa
    v_add_f32_dpp v33, v37, v37 row_shr:4 row_mask:0xf bank_mask:0xa
    v_add_f32_dpp v34, v38, v38 row_shr:4 row_mask:0xf bank_mask:0xa
    v_add_f32_dpp v35, v39, v39 row_shr:4 row_mask:0xf bank_mask:0xa
    s_nop 1
    v_add_f32_dpp v32, v32, v32 quad_perm:[1,0,3,2] row_mask:0xf bank_mask:0xf
    v_add_f32_dpp v33, v33, v33 quad_perm:[1,0,3,2] row_mask:0xf bank_mask:0xf
    v_add_f32_dpp v34, v34, v34 quad_perm:[1,0,3,2] row_mask:0xf bank_mask:0xf
    v_add_f32_dpp v35, v35, v35 quad_perm:[1,0,3,2] row_mask:0xf bank_mask:0xf
    s_nop 1
    v_add_f32_dpp v32, v32, v32 quad_perm:[2,3,0,1] row_mask:0xf bank_mask:0xf
    v_add_f32_dpp v33, v33, v33 quad_perm:[2,3,0,1] row_mask:0xf bank_mask:0xf
    v_add_f32_dpp v34, v34, v34 quad_perm:[2,3,0,1] row_mask:0xf bank_mask:0xf
    v_add_f32_dpp v35, v35, v35 quad_perm:[2,3,0,1] row_mask:0xf bank_mask:0xf
    v_mov_b32 v8, v9
    v_mov_b32 v9, v10
    v_mov_b32 v10, v11
    v_mov_b32 v11, v12
    v_cndmask_b32 v12, v32, v33, s[4:5]
    v_cndmask_b32 v12, v12, v34, s[6:7]
    v_cndmask_b32 v12, v12, v35, s[8:9]
    s_mov_b32 s81, 2
L_kloop:
    s_cmp_eq_u32 s81, s82
    s_cselect_b32 s15, s99, 16
    s_waitcnt vmcnt(1)
    v_dot2_f32_bf16 v32, v64, v4, 0
    v_dot2c_f32_bf16 v32, v65, v5
    v_dot2c_f32_bf16 v32, v66, v6
    v_dot2c_f32_bf16 v32, v67, v7
    buffer_load_dwordx4 v[64:67], v1, s[68:71], s75 offen nt
    s_add_u32 s75, s75, 16384
    s_waitcnt vmcnt(1)
    v_dot2_f32_bf16 v33, v68, v4, 0
    v_dot2c_f32_bf16 v33, v69, v5
    v_dot2c_f32_bf16 v33, v70, v6
    v_dot2c_f32_bf16 v33, v71, v7
    buffer_load_dwordx4 v[68:71], v1, s[68:71], s75 offen nt
    s_add_u32 s75, s75, 16384
    s_waitcnt vmcnt(1)
    v_dot2_f32_bf16 v34, v64, v4, 0
    v_dot2c_f32_bf16 v34, v65, v5
    v_dot2c_f32_bf16 v34, v66, v6
    v_dot2c_f32_bf16 v34, v67, v7
    buffer_load_dwordx4 v[64:67], v1, s[68:71], s75 offen nt
    s_add_u32 s75, s75, 16384
    s_waitcnt vmcnt(1)
    v_dot2_f32_bf16 v35, v68, v4, 0
    v_dot2c_f32_bf16 v35, v69, v5
    v_dot2c_f32_bf16 v35, v70, v6
    v_dot2c_f32_bf16 v35, v71, v7
    buffer_load_dwordx4 v[68:71], v1, s[68:71], s75 offen nt
    s_add_u32 s75, s75, 16384
    s_waitcnt vmcnt(1)
    v_dot2_f32_bf16 v36, v64, v4, 0
    v_dot2c_f32_bf16 v36, v65, v5
    v_dot2c_f32_bf16 v36, v66, v6
    v_dot2c_f32_bf16 v36, v67, v7
    buffer_load_dwordx4 v[64:67], v1, s[68:71], s75 offen nt
    s_add_u32 s75, s75, 16384
    s_waitcnt vmcnt(1)
    v_dot2_f32_bf16 v37, v68, v4, 0
    v_dot2c_f32_bf16 v37, v69, v5
    v_dot2c_f32_bf16 v37, v70, v6
    v_dot2c_f32_bf16 v37, v71, v7
    buffer_load_dwordx4 v[68:71], v1, s[68:71], s75 offen nt
    s_add_u32 s75, s75, 16384
    s_waitcnt vmcnt(1)
    v_dot2_f32_bf16 v38, v64, v4, 0
    v_dot2c_f32_bf16 v38, v65, v5
    v_dot2c_f32_bf16 v38, v66, v6
    v_dot2c_f32_bf16 v38, v67, v7
    buffer_load_dwordx4 v[64:67], v1, s[68:71], s75 offen nt
    s_add_u32 s75, s75, 16384
    s_waitcnt vmcnt(1)
    v_dot2_f32_bf16 v39, v68, v4, 0
    v_dot2c_f32_bf16 v39, v69, v5
    v_dot2c_f32_bf16 v39, v70, v6
    v_dot2c_f32_bf16 v39, v71, v7
    buffer_load_dwordx4 v[68:71], v1, s[68:71], s75 offen nt
    s_add_u32 s75, s75, 16384
    s_waitcnt vmcnt(1)
    v_dot2_f32_bf16 v40, v64, v4, 0
    v_dot2c_f32_bf16 v40, v65, v5
    v_dot2c_f32_bf16 v40, v66, v6
    v_dot2c_f32_bf16 v40, v67, v7
    buffer_load_dwordx4 v[64:67], v1, s[68:71], s75 offen nt
    s_add_u32 s75, s75, 16384
    s_waitcnt vmcnt(1)
    v_dot2_f32_bf16 v41, v68, v4, 0
    v_dot2c_f32_bf16 v41, v69, v5
    v_dot2c_f32_bf16 v41, v70, v6
    v_dot2c_f32_bf16 v41, v71, v7
    buffer_load_dwordx4 v[68:71], v1, s[68:71], s75 offen nt
    s_add_u32 s75, s75, 16384
    s_waitcnt vmcnt(1)
    v_dot2_f32_bf16 v42, v64, v4, 0
    v_dot2c_f32_bf16 v42, v65, v5
    v_dot2c_f32_bf16 v42, v66, v6
    v_dot2c_f32_bf16 v42, v67, v7
    buffer_load_dwordx4 v[64:67], v1, s[68:71], s75 offen nt
    s_add_u32 s75, s75, 16384
    s_waitcnt vmcnt(1)
    v_dot2_f32_bf16 v43, v68, v4, 0
    v_dot2c_f32_bf16 v43, v69, v5
    v_dot2c_f32_bf16 v43, v70, v6
    v_dot2c_f32_bf16 v43, v71, v7
    buffer_load_dwordx4 v[68:71], v1, s[68:71], s75 offen nt
    s_add_u32 s75, s75, 16384
    s_waitcnt vmcnt(1)
    v_dot2_f32_bf16 v44, v64, v4, 0
    v_dot2c_f32_bf16 v44, v65, v5
    v_dot2c_f32_bf16 v44, v66, v6
    v_dot2c_f32_bf16 v44, v67, v7
    buffer_load_dwordx4 v[64:67], v1, s[68:71], s75 offen nt
    s_add_u32 s75, s75, 16384
    s_waitcnt vmcnt(1)
    v_dot2_f32_bf16 v45, v68, v4, 0
    v_dot2c_f32_bf16 v45, v69, v5
    v_dot2c_f32_bf16 v45, v70, v6
    v_dot2c_f32_bf16 v45, v71, v7
    buffer_load_dwordx4 v[68:71], v1, s[68:71], s75 offen nt
    s_add_u32 s75, s75, 16384
    s_cmp_lg_u32 s81, s82
    s_cbranch_scc1 L_k1
    s_mov_b32 s68, s32
    s_mov_b32 s69, s33
    s_mov_b32 s70, s34
    s_mov_b32 s71, s35
    s_mov_b32 s75, s83
L_k1:
    s_waitcnt vmcnt(1)
    v_dot2_f32_bf16 v46, v64, v4, 0
    v_dot2c_f32_bf16 v46, v65, v5
    v_dot2c_f32_bf16 v46, v66, v6
    v_dot2c_f32_bf16 v46, v67, v7
    buffer_load_dwordx4 v[64:67], v1, s[68:71], s75 offen nt
    s_add_u32 s75, s75, 16384
    s_waitcnt vmcnt(1)
    v_dot2_f32_bf16 v47, v68, v4, 0
    v_dot2c_f32_bf16 v47, v69, v5
    v_dot2c_f32_bf16 v47, v70, v6
    v_dot2c_f32_bf16 v47, v71, v7
    buffer_load_dwordx4 v[68:71], v1, s[68:71], s75 offen nt
    s_add_u32 s75, s75, 16384
    s_nop 1
    v_add_f32_dpp v32, v32, v32 row_ror:8 row_mask:0xf bank_mask:0x3
    v_add_f32_dpp v33, v33, v33 row_ror:8 row_mask:0xf bank_mask:0x3
    v_add_f32_dpp v34, v34, v34 row_ror:8 row_mask:0xf bank_mask:0x3
    v_add_f32_dpp v35, v35, v35 row_ror:8 row_mask:0xf bank_mask:0x3
    v_add_f32_dpp v36, v36, v36 row_ror:8 row_mask:0xf bank_mask:0x3
    v_add_f32_dpp v37, v37, v37 row_ror:8 row_mask:0xf bank_mask:0x3
    v_add_f32_dpp v38, v38, v38 row_ror:8 row_mask:0xf bank_mask:0x3
    v_add_f32_dpp v39, v39, v39 row_ror:8 row_mask:0xf bank_mask:0x3
    v_add_f32_dpp v32, v40, v40 row_ror:8 row_mask:0xf bank_mask:0xc
    v_add_f32_dpp v33, v41, v41 row_ror:8 row_mask:0xf bank_mask:0xc
    v_add_f32_dpp v34, v42, v42 row_ror:8 row_mask:0xf bank_mask:0xc
    v_add_f32_dpp v35, v43, v43 row_ror:8 row_mask:0xf bank_mask:0xc
    v_add_f32_dpp v36, v44, v44 row_ror:8 row_mask:0xf bank_mask:0xc
    v_add_f32_dpp v37, v45, v45 row_ror:8 row_mask:0xf bank_mask:0xc
    v_add_f32_dpp v38, v46, v46 row_ror:8 row_mask:0xf bank_mask:0xc
    v_add_f32_dpp v39, v47, v47 row_ror:8 row_mask:0xf bank_mask:0xc
    s_nop 1
    v_add_f32_dpp v32, v32, v32 row_shl:4 row_mask:0xf bank_mask:0x5
    v_add_f32_dpp v33, v33, v33 row_shl:4 row_mask:0xf bank_mask:0x5
    v_add_f32_dpp v34, v34, v34 row_shl:4 row_mask:0xf bank_mask:0x5
    v_add_f32_dpp v35, v35, v35 row_shl:4 row_mask:0xf bank_mask:0x5
    v_add_f32_dpp v32, v36, v36 row_shr:4 row_mask:0xf bank_mask:0xa
    v_add_f32_dpp v33, v37, v37 row_shr:4 row_mask:0xf bank_mask:0xa
    v_add_f32_dpp v34, v38, v38 row_shr:4 row_mask:0xf bank_mask:0xa
    v_add_f32_dpp v35, v39, v39 row_shr:4 row_mask:0xf bank_mask:0xa
    s_nop 1
    v_add_f32_dpp v32, v32, v32 quad_perm:[1,0,3,2] row_mask:0xf bank_mask:0xf
    v_add_f32_dpp v33, v33, v33 quad_perm:[1,0,3,2] row_mask:0xf bank_mask:0xf
    v_add_f32_dpp v34, v34, v34 quad_perm:[1,0,3,2] row_mask:0xf bank_mask:0xf
    v_add_f32_dpp v35, v35, v35 quad_perm:[1,0,3,2] row_mask:0xf bank_mask:0xf
    s_nop 1
    v_add_f32_dpp v32, v32, v32 quad_perm:[2,3,0,1] row_mask:0xf bank_mask:0xf
    v_add_f32_dpp v33, v33, v33 quad_perm:[2,3,0,1] row_mask:0xf bank_mask:0xf
    v_add_f32_dpp v34, v34, v34 quad_perm:[2,3,0,1] row_mask:0xf bank_mask:0xf
    v_add_f32_dpp v35, v35, v35 quad_perm:[2,3,0,1] row_mask:0xf bank_mask:0xf
    v_mov_b32 v8, v9
    v_mov_b32 v9, v10
    v_mov_b32 v10, v11
    v_mov_b32 v11, v12
    v_cndmask_b32 v12, v32, v33, s[4:5]
    v_cndmask_b32 v12, v12, v34, s[6:7]
    v_cndmask_b32 v12, v12, v35, s[8:9]
    s_add_u32 s81, s81, 1
    s_cmp_le_u32 s81, s82
    s_cbranch_scc1 L_kloop
    s_branch L_kdone
L_kexit:
    s_mov_b32 s68, s32
    s_mov_b32 s69, s33
    s_mov_b32 s70, s34
    s_mov_b32 s71, s35
    s_mov_b32 s75, s83
    buffer_load_dwordx4 v[64:67], v1, s[68:71], s75 offen nt
    s_add_u32 s75, s75, 16384
    buffer_load_dwordx4 v[68:71], v1, s[68:71], s75 offen nt
    s_add_u32 s75, s75, 16384
    s_nop 1
    v_add_f32_dpp v32, v32, v32 row_ror:8 row_mask:0xf bank_mask:0x3
    v_add_f32_dpp v33, v33, v33 row_ror:8 row_mask:0xf bank_mask:0x3
    v_add_f32_dpp v34, v34, v34 row_ror:8 row_mask:0xf bank_mask:0x3
    v_add_f32_dpp v35, v35, v35 row_ror:8 row_mask:0xf bank_mask:0x3
    v_add_f32_dpp v36, v36, v36 row_ror:8 row_mask:0xf bank_mask:0x3
    v_add_f32_dpp v37, v37, v37 row_ror:8 row_mask:0xf bank_mask:0x3
    v_add_f32_dpp v38, v38, v38 row_ror:8 row_mask:0xf bank_mask:0x3
    v_add_f32_dpp v39, v39, v39 row_ror:8 row_mask:0xf bank_mask:0x3
    v_add_f32_dpp v32, v40, v40 row_ror:8 row_mask:0xf bank_mask:0xc
    v_add_f32_dpp v33, v41, v41 row_ror:8 row_mask:0xf bank_mask:0xc
    v_add_f32_dpp v34, v42, v42 row_ror:8 row_mask:0xf bank_mask:0xc
    v_add_f32_dpp v35, v43, v43 row_ror:8 row_mask:0xf bank_mask:0xc
    v_add_f32_dpp v36, v44, v44 row_ror:8 row_mask:0xf bank_mask:0xc
    v_add_f32_dpp v37, v45, v45 row_ror:8 row_mask:0xf bank_mask:0xc
    v_add_f32_dpp v38, v46, v46 row_ror:8 row_mask:0xf bank_mask:0xc
    v_add_f32_dpp v39, v47, v47 row_ror:8 row_mask:0xf bank_mask:0xc
    s_nop 1
    v_add_f32_dpp v32, v32, v32 row_shl:4 row_mask:0xf bank_mask:0x5
    v_add_f32_dpp v33, v33, v33 row_shl:4 row_mask:0xf bank_mask:0x5
    v_add_f32_dpp v34, v34, v34 row_shl:4 row_mask:0xf bank_mask:0x5
    v_add_f32_dpp v35, v35, v35 row_shl:4 row_mask:0xf bank_mask:0x5
    v_add_f32_dpp v32, v36, v36 row_shr:4 row_mask:0xf bank_mask:0xa
    v_add_f32_dpp v33, v37, v37 row_shr:4 row_mask:0xf bank_mask:0xa
    v_add_f32_dpp v34, v38, v38 row_shr:4 row_mask:0xf bank_mask:0xa
    v_add_f32_dpp v35, v39, v39 row_shr:4 row_mask:0xf bank_mask:0xa
    s_nop 1
    v_add_f32_dpp v32, v32, v32 quad_perm:[1,0,3,2] row_mask:0xf bank_mask:0xf
    v_add_f32_dpp v33, v33, v33 quad_perm:[1,0,3,2] row_mask:0xf bank_mask:0xf
    v_add_f32_dpp v34, v34, v34 quad_perm:[1,0,3,2] row_mask:0xf bank_mask:0xf
    v_add_f32_dpp v35, v35, v35 quad_perm:[1,0,3,2] row_mask:0xf bank_mask:0xf
    s_nop 1
    v_add_f32_dpp v32, v32, v32 quad_perm:[2,3,0,1] row_mask:0xf bank_mask:0xf
    v_add_f32_dpp v33, v33, v33 quad_perm:[2,3,0,1] row_mask:0xf bank_mask:0xf
    v_add_f32_dpp v34, v34, v34 quad_perm:[2,3,0,1] row_mask:0xf bank_mask:0xf
    v_add_f32_dpp v35, v35, v35 quad_perm:[2,3,0,1] row_mask:0xf bank_mask:0xf
    v_mov_b32 v8, v9
    v_mov_b32 v9, v10
    v_mov_b32 v10, v11
    v_mov_b32 v11, v12
    v_cndmask_b32 v12, v32, v33, s[4:5]
    v_cndmask_b32 v12, v12, v34, s[6:7]
    v_cndmask_b32 v12, v12, v35, s[8:9]
L_kdone:
    s_cmp_eq_u32 s82, 5
    s_cbranch_scc1 L_k5
    v_mov_b32 v8, v9
    v_mov_b32 v9, v10
    v_mov_b32 v10, v11
    v_mov_b32 v11, v12
L_k5:
    s_cmp_eq_u32 s78, 0xffff
    s_cbranch_scc1 L_noffn2
    s_and_b32 s76, s3, 7
    s_lshl_b32 s76, s76, 8
    v_lshrrev_b32 v2, 2, v0
    v_lshlrev_b32 v2, 2, v2
    v_add_u32 v2, s76, v2
    ds_read_b32 v24, v2 offset:4352
    ds_read_b32 v25, v2 offset:4416
    ds_read_b32 v26, v2 offset:4480
    ds_read_b32 v27, v2 offset:4544
    s_lshl_b32 s76, s78, 5
    s_lshl_b32 s77, s3, 1
    s_add_u32 s76, s76, s77
    s_lshl_b32 s76, s76, 10
    buffer_load_dwordx4 v[32:35], v1, s[52:55], s76 offen nt
    buffer_load_dwordx4 v[36:39], v1, s[52:55], s76 offen offset:1024 nt
    s_waitcnt lgkmcnt(0)
    v_lshlrev_b32 v2, 16, v48
    v_and_b32 v3, s80, v48
    v_mul_f32 v16, v24, v2
    v_mul_f32 v17, v24, v3
    v_lshlrev_b32 v2, 16, v49
    v_and_b32 v3, s80, v49
    v_mul_f32 v18, v24, v2
    v_mul_f32 v19, v24, v3
    v_lshlrev_b32 v2, 16, v50
    v_and_b32 v3, s80, v50
    v_mul_f32 v20, v24, v2
    v_mul_f32 v21, v24, v3
    v_lshlrev_b32 v2, 16, v51
    v_and_b32 v3, s80, v51
    v_mul_f32 v22, v24, v2
    v_mul_f32 v23, v24, v3
    v_lshlrev_b32 v2, 16, v52
    v_and_b32 v3, s80, v52
    v_fmac_f32 v16, v25, v2
    v_fmac_f32 v17, v25, v3
    v_lshlrev_b32 v2, 16, v53
    v_and_b32 v3, s80, v53
    v_fmac_f32 v18, v25, v2
    v_fmac_f32 v19, v25, v3
    v_lshlrev_b32 v2, 16, v54
    v_and_b32 v3, s80, v54
    v_fmac_f32 v20, v25, v2
    v_fmac_f32 v21, v25, v3
    v_lshlrev_b32 v2, 16, v55
    v_and_b32 v3, s80, v55
    v_fmac_f32 v22, v25, v2
    v_fmac_f32 v23, v25, v3
    v_lshlrev_b32 v2, 16, v56
    v_and_b32 v3, s80, v56
    v_fmac_f32 v16, v26, v2
    v_fmac_f32 v17, v26, v3
    v_lshlrev_b32 v2, 16, v57
    v_and_b32 v3, s80, v57
    v_fmac_f32 v18, v26, v2
    v_fmac_f32 v19, v26, v3
    v_lshlrev_b32 v2, 16, v58
    v_and_b32 v3, s80, v58
    v_fmac_f32 v20, v26, v2
    v_fmac_f32 v21, v26, v3
    v_lshlrev_b32 v2, 16, v59
    v_and_b32 v3, s80, v59
    v_fmac_f32 v22, v26, v2
    v_fmac_f32 v23, v26, v3
    v_lshlrev_b32 v2, 16, v60
    v_and_b32 v3, s80, v60
    v_fmac_f32 v16, v27, v2
    v_fmac_f32 v17, v27, v3
    v_lshlrev_b32 v2, 16, v61
    v_and_b32 v3, s80, v61
    v_fmac_f32 v18, v27, v2
    v_fmac_f32 v19, v27, v3
    v_lshlrev_b32 v2, 16, v62
    v_and_b32 v3, s80, v62
    v_fmac_f32 v20, v27, v2
    v_fmac_f32 v21, v27, v3
    v_lshlrev_b32 v2, 16, v63
    v_and_b32 v3, s80, v63
    v_fmac_f32 v22, v27, v2
    v_fmac_f32 v23, v27, v3
    s_nop 1
    v_permlane32_swap_b32 v16, v20
    v_permlane32_swap_b32 v17, v21
    v_permlane32_swap_b32 v18, v22
    v_permlane32_swap_b32 v19, v23
    s_nop 0
    v_add_f32 v16, v16, v20
    v_add_f32 v17, v17, v21
    v_add_f32 v18, v18, v22
    v_add_f32 v19, v19, v23
    s_nop 1
    v_permlane16_swap_b32 v16, v18
    v_permlane16_swap_b32 v17, v19
    s_nop 0
    v_add_f32 v16, v16, v18
    v_add_f32 v17, v17, v19
    s_nop 1
    v_add_f32_dpp v16, v16, v16 row_ror:8 row_mask:0xf bank_mask:0xf
    v_add_f32_dpp v17, v17, v17 row_ror:8 row_mask:0xf bank_mask:0xf
    s_nop 1
    v_add_f32_dpp v16, v16, v16 row_ror:4 row_mask:0xf bank_mask:0xf
    v_add_f32_dpp v17, v17, v17 row_ror:4 row_mask:0xf bank_mask:0xf
    v_and_b32 v2, 3, v0
    v_lshlrev_b32 v2, 5, v2
    v_lshrrev_b32 v3, 4, v0
    v_lshl_add_u32 v2, v3, 3, v2
    s_lshl_b32 s76, s3, 7
    v_add_u32 v2, s76, v2
    ds_write_b64 v2, v[16:17] offset:6400
L_noffn2:
    v_cvt_pk_bf16_f32 v24, v8, v9
    v_cvt_pk_bf16_f32 v25, v10, v11
    v_cvt_pk_bf16_f32 v26, v12, v12
    v_lshlrev_b32 v8, 16, v24
    v_and_b32 v9, s80, v24
    v_lshlrev_b32 v10, 16, v25
    v_and_b32 v11, s80, v25
    v_lshlrev_b32 v12, 16, v26
    v_mul_f32 v8, 0x3db504f3, v8
    v_mul_f32 v9, 0x3db504f3, v9
    v_mul_f32 v10, 0x3db504f3, v10
    v_mul_f32 v11, 0x3db504f3, v11
    v_mul_f32 v12, 0x3db504f3, v12
    v_cvt_pk_bf16_f32 v24, v8, v9
    v_cvt_pk_bf16_f32 v25, v10, v11
    v_cvt_pk_bf16_f32 v26, v12, v12
    v_lshlrev_b32 v8, 16, v24
    v_and_b32 v9, s80, v24
    v_lshlrev_b32 v10, 16, v25
    v_and_b32 v11, s80, v25
    v_lshlrev_b32 v12, 16, v26
    v_and_b32 v2, 15, v0
    v_lshlrev_b32 v2, 4, v2
    v_add_u32 v2, s3, v2
    v_mov_b32 v3, 0xf149f2ca
    v_add_u32 v24, 768, v2
    v_cmp_gt_u32 vcc, s74, v24
    s_nop 1
    v_cndmask_b32 v11, v3, v11, vcc
    v_add_u32 v24, 1024, v2
    v_cmp_gt_u32 vcc, s74, v24
    s_nop 1
    v_cndmask_b32 v12, v3, v12, vcc
    v_max3_f32 v2, v8, v9, v10
    v_max3_f32 v2, v2, v11, v12
    s_nop 1
    v_max_f32_dpp v2, v2, v2 row_ror:8 row_mask:0xf bank_mask:0xf
    s_nop 1
    v_max_f32_dpp v2, v2, v2 row_ror:4 row_mask:0xf bank_mask:0xf
    s_nop 1
    v_max_f32_dpp v2, v2, v2 row_ror:2 row_mask:0xf bank_mask:0xf
    s_nop 1
    v_max_f32_dpp v2, v2, v2 row_ror:1 row_mask:0xf bank_mask:0xf
    v_mov_b32 v3, v2
    s_nop 1
    v_permlane16_swap_b32 v2, v3
    s_nop 0
    v_max_f32 v2, v2, v3
    v_mov_b32 v3, v2
    s_nop 1
    v_permlane32_swap_b32 v2, v3
    s_nop 0
    v_max_f32 v2, v2, v3
    v_sub_f32 v8, v8, v2
    v_sub_f32 v9, v9, v2
    v_sub_f32 v10, v10, v2
    v_sub_f32 v11, v11, v2
    v_sub_f32 v12, v12, v2
    v_mul_f32 v8, 0x3fb8aa3b, v8
    v_mul_f32 v9, 0x3fb8aa3b, v9
    v_mul_f32 v10, 0x3fb8aa3b, v10
    v_mul_f32 v11, 0x3fb8aa3b, v11
    v_mul_f32 v12, 0x3fb8aa3b, v12
    v_exp_f32 v8, v8
    v_exp_f32 v9, v9
    v_exp_f32 v10, v10
    v_exp_f32 v11, v11
    v_exp_f32 v12, v12
    s_nop 0
    v_add_f32 v3, v8, v9
    v_add_f32 v3, v3, v10
    v_add_f32 v3, v3, v11
    v_add_f32 v3, v3, v12
    s_nop 1
    v_add_f32_dpp v3, v3, v3 row_ror:8 row_mask:0xf bank_mask:0xf
    s_nop 1
    v_add_f32_dpp v3, v3, v3 row_ror:4 row_mask:0xf bank_mask:0xf
    s_nop 1
    v_add_f32_dpp v3, v3, v3 row_ror:2 row_mask:0xf bank_mask:0xf
    s_nop 1
    v_add_f32_dpp v3, v3, v3 row_ror:1 row_mask:0xf bank_mask:0xf
    v_mov_b32 v24, v3
    s_nop 1
    v_permlane16_swap_b32 v3, v24
    s_nop 0
    v_add_f32 v3, v3, v24
    v_mov_b32 v24, v3
    s_nop 1
    v_permlane32_swap_b32 v3, v24
    s_nop 0
    v_add_f32 v3, v3, v24
    s_lshl_b32 s76, s3, 3
    v_mov_b32 v24, s76
    ds_write_b64 v24, v[2:3] offset:8512
    s_waitcnt lgkmcnt(0)
    v_mov_b32 v24, 8448
    v_mov_b32 v25, 1
    s_mov_b64 exec, 1
    ds_add_u32 v24, v25 offset:12
    s_mov_b64 exec, -1
    s_waitcnt vmcnt(1)
    buffer_load_dwordx4 v[72:75], v1, s[32:35], s75 offen nt
    s_add_u32 s75, s75, 16384
    s_waitcnt vmcnt(1)
    buffer_load_dwordx4 v[76:79], v1, s[32:35], s75 offen nt
    s_add_u32 s75, s75, 16384
    s_waitcnt vmcnt(1)
    buffer_load_dwordx4 v[80:83], v1, s[32:35], s75 offen nt
    s_add_u32 s75, s75, 16384
    s_waitcnt vmcnt(1)
    buffer_load_dwordx4 v[84:87], v1, s[32:35], s75 offen nt
    s_add_u32 s75, s75, 16384
    s_waitcnt vmcnt(1)
    buffer_load_dwordx4 v[88:91], v1, s[32:35], s75 offen nt
    s_add_u32 s75, s75, 16384
    s_waitcnt vmcnt(1)
    buffer_load_dwordx4 v[92:95], v1, s[32:35], s75 offen nt
    s_add_u32 s75, s75, 16384
    s_waitcnt vmcnt(1)
    buffer_load_dwordx4 v[96:99], v1, s[32:35], s75 offen nt
    s_add_u32 s75, s75, 16384
    s_waitcnt vmcnt(1)
    buffer_load_dwordx4 v[100:103], v1, s[32:35], s75 offen nt
    s_add_u32 s75, s75, 16384
    s_waitcnt vmcnt(1)
    buffer_load_dwordx4 v[104:107], v1, s[32:35], s75 offen nt
    s_add_u32 s75, s75, 16384
    s_waitcnt vmcnt(1)
    buffer_load_dwordx4 v[108:111], v1, s[32:35], s75 offen nt
    s_add_u32 s75, s75, 16384
    s_waitcnt vmcnt(1)
    buffer_load_dwordx4 v[112:115], v1, s[32:35], s75 offen nt
    s_add_u32 s75, s75, 16384
    s_waitcnt vmcnt(1)
    buffer_load_dwordx4 v[116:119], v1, s[32:35], s75 offen nt
    s_add_u32 s75, s75, 16384
    s_waitcnt vmcnt(1)
    buffer_load_dwordx4 v[120:123], v1, s[32:35], s75 offen nt
    s_add_u32 s75, s75, 16384
    s_waitcnt vmcnt(1)
    buffer_load_dwordx4 v[124:127], v1, s[32:35], s75 offen nt
    s_add_u32 s75, s75, 16384
    s_mov_b32 s97, 0
L_mwait:
    ds_read_b32 v25, v24 offset:12
    s_waitcnt lgkmcnt(0)
    v_readfirstlane_b32 s76, v25
    s_add_u32 s97, s97, 1
    s_cmp_gt_u32 s97, 2000000
    s_cbranch_scc1 L_mok
    s_cmp_ge_u32 s76, 16
    s_cbranch_scc1 L_mok
    s_sleep 2
    s_branch L_mwait
L_mok:
    v_and_b32 v24, 15, v0
    v_lshlrev_b32 v24, 3, v24
    ds_read_b64 v[26:27], v24 offset:8512
    s_waitcnt lgkmcnt(0)
    v_mov_b32 v28, v26
    s_nop 1
    v_max_f32_dpp v28, v28, v28 row_ror:8 row_mask:0xf bank_mask:0xf
    s_nop 1
    v_max_f32_dpp v28, v28, v28 row_ror:4 row_mask:0xf bank_mask:0xf
    s_nop 1
    v_max_f32_dpp v28, v28, v28 row_ror:2 row_mask:0xf bank_mask:0xf
    s_nop 1
    v_max_f32_dpp v28, v28, v28 row_ror:1 row_mask:0xf bank_mask:0xf
    v_sub_f32 v26, v26, v28
    v_sub_f32 v2, v2, v28
    v_mul_f32 v26, 0x3fb8aa3b, v26
    v_mul_f32 v2, 0x3fb8aa3b, v2
    v_exp_f32 v26, v26
    v_exp_f32 v2, v2
    s_nop 0
    v_mul_f32 v29, v26, v27
    s_nop 1
    v_add_f32_dpp v29, v29, v29 row_ror:8 row_mask:0xf bank_mask:0xf
    s_nop 1
    v_add_f32_dpp v29, v29, v29 row_ror:4 row_mask:0xf bank_mask:0xf
    s_nop 1
    v_add_f32_dpp v29, v29, v29 row_ror:2 row_mask:0xf bank_mask:0xf
    s_nop 1
    v_add_f32_dpp v29, v29, v29 row_ror:1 row_mask:0xf bank_mask:0xf
    v_mul_f32 v8, v8, v2
    v_mul_f32 v9, v9, v2
    v_mul_f32 v10, v10, v2
    v_mul_f32 v11, v11, v2
    v_mul_f32 v12, v12, v2
    v_readfirstlane_b32 s79, v28
    s_cmp_lg_u32 s3, 0
    s_cbranch_scc1 L_nopub
    s_lshl_b32 s76, s72, 3
    s_add_u32 s76, s76, s73
    s_lshl_b32 s76, s76, 3
    s_add_u32 s76, s76, 49152
    s_mov_b64 exec, 1
    buffer_store_dwordx2 v[28:29], off, s[64:67], s76 sc1
    s_mov_b64 exec, -1
L_nopub:
    s_cmp_eq_u32 s78, 0xffff
    s_cbranch_scc1 L_noffn4
    v_and_b32 v2, 31, v0
    v_lshlrev_b32 v2, 2, v2
    ds_read_b32 v40, v2 offset:6400
    ds_read_b32 v41, v2 offset:6528
    ds_read_b32 v42, v2 offset:6656
    ds_read_b32 v43, v2 offset:6784
    ds_read_b32 v44, v2 offset:6912
    ds_read_b32 v45, v2 offset:7040
    ds_read_b32 v46, v2 offset:7168
    ds_read_b32 v47, v2 offset:7296
    ds_read_b32 v48, v2 offset:7424
    ds_read_b32 v49, v2 offset:7552
    ds_read_b32 v50, v2 offset:7680
    ds_read_b32 v51, v2 offset:7808
    ds_read_b32 v52, v2 offset:7936
    ds_read_b32 v53, v2 offset:8064
    ds_read_b32 v54, v2 offset:8192
    ds_read_b32 v55, v2 offset:8320
    s_waitcnt lgkmcnt(0)
    v_add_f32 v40, v40, v41
    v_add_f32 v40, v40, v42
    v_add_f32 v40, v40, v43
    v_add_f32 v40, v40, v44
    v_add_f32 v40, v40, v45
    v_add_f32 v40, v40, v46
    v_add_f32 v40, v40, v47
    v_add_f32 v48, v48, v49
    v_add_f32 v48, v48, v50
    v_add_f32 v48, v48, v51
    v_add_f32 v48, v48, v52
    v_add_f32 v48, v48, v53
    v_add_f32 v48, v48, v54
    v_add_f32 v48, v48, v55
    v_cvt_pk_bf16_f32 v40, v40, v40
    v_lshlrev_b32 v40, 16, v40
    v_cvt_pk_bf16_f32 v48, v48, v48
    v_lshlrev_b32 v48, 16, v48
    v_mul_f32 v2, v40, v40
    v_mul_f32 v2, v2, v40
    v_mov_b32 v3, 0x3d372713
    v_fma_f32 v2, v2, v3, v40
    v_mul_f32 v2, 0x40135761, v2
    v_exp_f32 v2, v2
    s_nop 0
    v_add_f32 v2, 1.0, v2
    v_rcp_f32 v2, v2
    s_nop 0
    v_sub_f32 v2, 1.0, v2
    v_mul_f32 v2, v2, v40
    v_cvt_pk_bf16_f32 v2, v2, v2
    v_lshlrev_b32 v2, 16, v2
    v_mul_f32 v2, v2, v48
    v_cvt_pk_bf16_f32 v2, v2, v2
    v_lshlrev_b32 v2, 16, v2
    s_lshl_b32 s77, s3, 1
    s_nop 0
    v_readlane_b32 s84, v2, s77
    s_add_u32 s77, s77, 1
    v_readlane_b32 s85, v2, s77
    s_waitcnt vmcnt(0)
    s_nop 1
    v_lshlrev_b32 v2, 16, v32
    v_and_b32 v3, s80, v32
    v_mul_f32 v16, s84, v2
    v_mul_f32 v17, s84, v3
    v_lshlrev_b32 v2, 16, v33
    v_and_b32 v3, s80, v33
    v_mul_f32 v18, s84, v2
    v_mul_f32 v19, s84, v3
    v_lshlrev_b32 v2, 16, v34
    v_and_b32 v3, s80, v34
    v_mul_f32 v20, s84, v2
    v_mul_f32 v21, s84, v3
    v_lshlrev_b32 v2, 16, v35
    v_and_b32 v3, s80, v35
    v_mul_f32 v22, s84, v2
    v_mul_f32 v23, s84, v3
    v_lshlrev_b32 v2, 16, v36
    v_and_b32 v3, s80, v36
    v_fmac_f32 v16, s85, v2
    v_fmac_f32 v17, s85, v3
    v_lshlrev_b32 v2, 16, v37
    v_and_b32 v3, s80, v37
    v_fmac_f32 v18, s85, v2
    v_fmac_f32 v19, s85, v3
    v_lshlrev_b32 v2, 16, v38
    v_and_b32 v3, s80, v38
    v_fmac_f32 v20, s85, v2
    v_fmac_f32 v21, s85, v3
    v_lshlrev_b32 v2, 16, v39
    v_and_b32 v3, s80, v39
    v_fmac_f32 v22, s85, v2
    v_fmac_f32 v23, s85, v3
    ds_add_f32 v1, v16 offset:8704
    ds_add_f32 v1, v17 offset:8708
    ds_add_f32 v1, v18 offset:8712
    ds_add_f32 v1, v19 offset:8716
    ds_add_f32 v1, v20 offset:9728
    ds_add_f32 v1, v21 offset:9732
    ds_add_f32 v1, v22 offset:9736
    ds_add_f32 v1, v23 offset:9740
L_noffn4:
    s_lshl_b32 s76, s72, 7
    s_lshl_b32 s77, s73, 4
    s_add_u32 s76, s76, s77
    s_add_u32 s76, s76, s3
    s_lshl_b32 s76, s76, 10
    buffer_load_dwordx4 v[44:47], v1, s[40:43], s76 offen nt
    v_mov_b32 v16, 0
    v_mov_b32 v17, 0
    v_mov_b32 v18, 0
    v_mov_b32 v19, 0
    v_mov_b32 v20, 0
    v_mov_b32 v21, 0
    v_mov_b32 v22, 0
    v_mov_b32 v23, 0
    v_and_b32 v13, 7, v0
    v_lshlrev_b32 v13, 3, v13
    s_waitcnt vmcnt(16)
    v_lshlrev_b32 v24, 16, v64
    v_and_b32 v25, s80, v64
    v_lshlrev_b32 v26, 16, v65
    v_and_b32 v27, s80, v65
    v_lshlrev_b32 v28, 16, v66
    v_and_b32 v29, s80, v66
    v_lshlrev_b32 v30, 16, v67
    v_and_b32 v31, s80, v67
    v_fmac_f32_dpp v16, v8, v24 row_newbcast:0 row_mask:0xf bank_mask:0xf
    v_fmac_f32_dpp v17, v8, v25 row_newbcast:0 row_mask:0xf bank_mask:0xf
    v_fmac_f32_dpp v18, v8, v26 row_newbcast:0 row_mask:0xf bank_mask:0xf
    v_fmac_f32_dpp v19, v8, v27 row_newbcast:0 row_mask:0xf bank_mask:0xf
    v_fmac_f32_dpp v20, v8, v28 row_newbcast:0 row_mask:0xf bank_mask:0xf
    v_fmac_f32_dpp v21, v8, v29 row_newbcast:0 row_mask:0xf bank_mask:0xf
    v_fmac_f32_dpp v22, v8, v30 row_newbcast:0 row_mask:0xf bank_mask:0xf
    v_fmac_f32_dpp v23, v8, v31 row_newbcast:0 row_mask:0xf bank_mask:0xf
    buffer_load_dwordx4 v[64:67], v1, s[68:71], s75 offen nt
    s_add_u32 s75, s75, 16384
    s_waitcnt vmcnt(16)
    v_lshlrev_b32 v24, 16, v68
    v_and_b32 v25, s80, v68
    v_lshlrev_b32 v26, 16, v69
    v_and_b32 v27, s80, v69
    v_lshlrev_b32 v28, 16, v70
    v_and_b32 v29, s80, v70
    v_lshlrev_b32 v30, 16, v71
    v_and_b32 v31, s80, v71
    v_fmac_f32_dpp v16, v8, v24 row_newbcast:1 row_mask:0xf bank_mask:0xf
    v_fmac_f32_dpp v17, v8, v25 row_newbcast:1 row_mask:0xf bank_mask:0xf
    v_fmac_f32_dpp v18, v8, v26 row_newbcast:1 row_mask:0xf bank_mask:0xf
    v_fmac_f32_dpp v19, v8, v27 row_newbcast:1 row_mask:0xf bank_mask:0xf
    v_fmac_f32_dpp v20, v8, v28 row_newbcast:1 row_mask:0xf bank_mask:0xf
    v_fmac_f32_dpp v21, v8, v29 row_newbcast:1 row_mask:0xf bank_mask:0xf
    v_fmac_f32_dpp v22, v8, v30 row_newbcast:1 row_mask:0xf bank_mask:0xf
    v_fmac_f32_dpp v23, v8, v31 row_newbcast:1 row_mask:0xf bank_mask:0xf
    buffer_load_dwordx4 v[68:71], v1, s[68:71], s75 offen nt
    s_add_u32 s75, s75, 16384
    s_waitcnt vmcnt(16)
    v_lshlrev_b32 v24, 16, v72
    v_and_b32 v25, s80, v72
    v_lshlrev_b32 v26, 16, v73
    v_and_b32 v27, s80, v73
    v_lshlrev_b32 v28, 16, v74
    v_and_b32 v29, s80, v74
    v_lshlrev_b32 v30, 16, v75
    v_and_b32 v31, s80, v75
    v_fmac_f32_dpp v16, v8, v24 row_newbcast:2 row_mask:0xf bank_mask:0xf
    v_fmac_f32_dpp v17, v8, v25 row_newbcast:2 row_mask:0xf bank_mask:0xf
    v_fmac_f32_dpp v18, v8, v26 row_newbcast:2 row_mask:0xf bank_mask:0xf
    v_fmac_f32_dpp v19, v8, v27 row_newbcast:2 row_mask:0xf bank_mask:0xf
    v_fmac_f32_dpp v20, v8, v28 row_newbcast:2 row_mask:0xf bank_mask:0xf
    v_fmac_f32_dpp v21, v8, v29 row_newbcast:2 row_mask:0xf bank_mask:0xf
    v_fmac_f32_dpp v22, v8, v30 row_newbcast:2 row_mask:0xf bank_mask:0xf
    v_fmac_f32_dpp v23, v8, v31 row_newbcast:2 row_mask:0xf bank_mask:0xf
    s_waitcnt vmcnt(15)
    v_lshlrev_b32 v24, 16, v76
    v_and_b32 v25, s80, v76
    v_lshlrev_b32 v26, 16, v77
    v_and_b32 v27, s80, v77
    v_lshlrev_b32 v28, 16, v78
    v_and_b32 v29, s80, v78
    v_lshlrev_b32 v30, 16, v79
    v_and_b32 v31, s80, v79
    v_fmac_f32_dpp v16, v8, v24 row_newbcast:3 row_mask:0xf bank_mask:0xf
    v_fmac_f32_dpp v17, v8, v25 row_newbcast:3 row_mask:0xf bank_mask:0xf
    v_fmac_f32_dpp v18, v8, v26 row_newbcast:3 row_mask:0xf bank_mask:0xf
    v_fmac_f32_dpp v19, v8, v27 row_newbcast:3 row_mask:0xf bank_mask:0xf
    v_fmac_f32_dpp v20, v8, v28 row_newbcast:3 row_mask:0xf bank_mask:0xf
    v_fmac_f32_dpp v21, v8, v29 row_newbcast:3 row_mask:0xf bank_mask:0xf
    v_fmac_f32_dpp v22, v8, v30 row_newbcast:3 row_mask:0xf bank_mask:0xf
    v_fmac_f32_dpp v23, v8, v31 row_newbcast:3 row_mask:0xf bank_mask:0xf
    s_waitcnt vmcnt(14)
    v_lshlrev_b32 v24, 16, v80
    v_and_b32 v25, s80, v80
    v_lshlrev_b32 v26, 16, v81
    v_and_b32 v27, s80, v81
    v_lshlrev_b32 v28, 16, v82
    v_and_b32 v29, s80, v82
    v_lshlrev_b32 v30, 16, v83
    v_and_b32 v31, s80, v83
    v_fmac_f32_dpp v16, v8, v24 row_newbcast:4 row_mask:0xf bank_mask:0xf
    v_fmac_f32_dpp v17, v8, v25 row_newbcast:4 row_mask:0xf bank_mask:0xf
    v_fmac_f32_dpp v18, v8, v26 row_newbcast:4 row_mask:0xf bank_mask:0xf
    v_fmac_f32_dpp v19, v8, v27 row_newbcast:4 row_mask:0xf bank_mask:0xf
    v_fmac_f32_dpp v20, v8, v28 row_newbcast:4 row_mask:0xf bank_mask:0xf
    v_fmac_f32_dpp v21, v8, v29 row_newbcast:4 row_mask:0xf bank_mask:0xf
    v_fmac_f32_dpp v22, v8, v30 row_newbcast:4 row_mask:0xf bank_mask:0xf
    v_fmac_f32_dpp v23, v8, v31 row_newbcast:4 row_mask:0xf bank_mask:0xf
    s_waitcnt vmcnt(13)
    v_lshlrev_b32 v24, 16, v84
    v_and_b32 v25, s80, v84
    v_lshlrev_b32 v26, 16, v85
    v_and_b32 v27, s80, v85
    v_lshlrev_b32 v28, 16, v86
    v_and_b32 v29, s80, v86
    v_lshlrev_b32 v30, 16, v87
    v_and_b32 v31, s80, v87
    v_fmac_f32_dpp v16, v8, v24 row_newbcast:5 row_mask:0xf bank_mask:0xf
    v_fmac_f32_dpp v17, v8, v25 row_newbcast:5 row_mask:0xf bank_mask:0xf
    v_fmac_f32_dpp v18, v8, v26 row_newbcast:5 row_mask:0xf bank_mask:0xf
    v_fmac_f32_dpp v19, v8, v27 row_newbcast:5 row_mask:0xf bank_mask:0xf
    v_fmac_f32_dpp v20, v8, v28 row_newbcast:5 row_mask:0xf bank_mask:0xf
    v_fmac_f32_dpp v21, v8, v29 row_newbcast:5 row_mask:0xf bank_mask:0xf
    v_fmac_f32_dpp v22, v8, v30 row_newbcast:5 row_mask:0xf bank_mask:0xf
    v_fmac_f32_dpp v23, v8, v31 row_newbcast:5 row_mask:0xf bank_mask:0xf
    s_waitcnt vmcnt(12)
    v_lshlrev_b32 v24, 16, v88
    v_and_b32 v25, s80, v88
    v_lshlrev_b32 v26, 16, v89
    v_and_b32 v27, s80, v89
    v_lshlrev_b32 v28, 16, v90
    v_and_b32 v29, s80, v90
    v_lshlrev_b32 v30, 16, v91
    v_and_b32 v31, s80, v91
    v_fmac_f32_dpp v16, v8, v24 row_newbcast:6 row_mask:0xf bank_mask:0xf
    v_fmac_f32_dpp v17, v8, v25 row_newbcast:6 row_mask:0xf bank_mask:0xf
    v_fmac_f32_dpp v18, v8, v26 row_newbcast:6 row_mask:0xf bank_mask:0xf
    v_fmac_f32_dpp v19, v8, v27 row_newbcast:6 row_mask:0xf bank_mask:0xf
    v_fmac_f32_dpp v20, v8, v28 row_newbcast:6 row_mask:0xf bank_mask:0xf
    v_fmac_f32_dpp v21, v8, v29 row_newbcast:6 row_mask:0xf bank_mask:0xf
    v_fmac_f32_dpp v22, v8, v30 row_newbcast:6 row_mask:0xf bank_mask:0xf
    v_fmac_f32_dpp v23, v8, v31 row_newbcast:6 row_mask:0xf bank_mask:0xf
    s_waitcnt vmcnt(11)
    v_lshlrev_b32 v24, 16, v92
    v_and_b32 v25, s80, v92
    v_lshlrev_b32 v26, 16, v93
    v_and_b32 v27, s80, v93
    v_lshlrev_b32 v28, 16, v94
    v_and_b32 v29, s80, v94
    v_lshlrev_b32 v30, 16, v95
    v_and_b32 v31, s80, v95
    v_fmac_f32_dpp v16, v8, v24 row_newbcast:7 row_mask:0xf bank_mask:0xf
    v_fmac_f32_dpp v17, v8, v25 row_newbcast:7 row_mask:0xf bank_mask:0xf
    v_fmac_f32_dpp v18, v8, v26 row_newbcast:7 row_mask:0xf bank_mask:0xf
    v_fmac_f32_dpp v19, v8, v27 row_newbcast:7 row_mask:0xf bank_mask:0xf
    v_fmac_f32_dpp v20, v8, v28 row_newbcast:7 row_mask:0xf bank_mask:0xf
    v_fmac_f32_dpp v21, v8, v29 row_newbcast:7 row_mask:0xf bank_mask:0xf
    v_fmac_f32_dpp v22, v8, v30 row_newbcast:7 row_mask:0xf bank_mask:0xf
    v_fmac_f32_dpp v23, v8, v31 row_newbcast:7 row_mask:0xf bank_mask:0xf
    s_waitcnt vmcnt(10)
    v_lshlrev_b32 v24, 16, v96
    v_and_b32 v25, s80, v96
    v_lshlrev_b32 v26, 16, v97
    v_and_b32 v27, s80, v97
    v_lshlrev_b32 v28, 16, v98
    v_and_b32 v29, s80, v98
    v_lshlrev_b32 v30, 16, v99
    v_and_b32 v31, s80, v99
    v_fmac_f32_dpp v16, v8, v24 row_newbcast:8 row_mask:0xf bank_mask:0xf
    v_fmac_f32_dpp v17, v8, v25 row_newbcast:8 row_mask:0xf bank_mask:0xf
    v_fmac_f32_dpp v18, v8, v26 row_newbcast:8 row_mask:0xf bank_mask:0xf
    v_fmac_f32_dpp v19, v8, v27 row_newbcast:8 row_mask:0xf bank_mask:0xf
    v_fmac_f32_dpp v20, v8, v28 row_newbcast:8 row_mask:0xf bank_mask:0xf
    v_fmac_f32_dpp v21, v8, v29 row_newbcast:8 row_mask:0xf bank_mask:0xf
    v_fmac_f32_dpp v22, v8, v30 row_newbcast:8 row_mask:0xf bank_mask:0xf
    v_fmac_f32_dpp v23, v8, v31 row_newbcast:8 row_mask:0xf bank_mask:0xf
    s_waitcnt vmcnt(9)
    v_lshlrev_b32 v24, 16, v100
    v_and_b32 v25, s80, v100
    v_lshlrev_b32 v26, 16, v101
    v_and_b32 v27, s80, v101
    v_lshlrev_b32 v28, 16, v102
    v_and_b32 v29, s80, v102
    v_lshlrev_b32 v30, 16, v103
    v_and_b32 v31, s80, v103
    v_fmac_f32_dpp v16, v8, v24 row_newbcast:9 row_mask:0xf bank_mask:0xf
    v_fmac_f32_dpp v17, v8, v25 row_newbcast:9 row_mask:0xf bank_mask:0xf
    v_fmac_f32_dpp v18, v8, v26 row_newbcast:9 row_mask:0xf bank_mask:0xf
    v_fmac_f32_dpp v19, v8, v27 row_newbcast:9 row_mask:0xf bank_mask:0xf
    v_fmac_f32_dpp v20, v8, v28 row_newbcast:9 row_mask:0xf bank_mask:0xf
    v_fmac_f32_dpp v21, v8, v29 row_newbcast:9 row_mask:0xf bank_mask:0xf
    v_fmac_f32_dpp v22, v8, v30 row_newbcast:9 row_mask:0xf bank_mask:0xf
    v_fmac_f32_dpp v23, v8, v31 row_newbcast:9 row_mask:0xf bank_mask:0xf
    s_waitcnt vmcnt(8)
    v_lshlrev_b32 v24, 16, v104
    v_and_b32 v25, s80, v104
    v_lshlrev_b32 v26, 16, v105
    v_and_b32 v27, s80, v105
    v_lshlrev_b32 v28, 16, v106
    v_and_b32 v29, s80, v106
    v_lshlrev_b32 v30, 16, v107
    v_and_b32 v31, s80, v107
    v_fmac_f32_dpp v16, v8, v24 row_newbcast:10 row_mask:0xf bank_mask:0xf
    v_fmac_f32_dpp v17, v8, v25 row_newbcast:10 row_mask:0xf bank_mask:0xf
    v_fmac_f32_dpp v18, v8, v26 row_newbcast:10 row_mask:0xf bank_mask:0xf
    v_fmac_f32_dpp v19, v8, v27 row_newbcast:10 row_mask:0xf bank_mask:0xf
    v_fmac_f32_dpp v20, v8, v28 row_newbcast:10 row_mask:0xf bank_mask:0xf
    v_fmac_f32_dpp v21, v8, v29 row_newbcast:10 row_mask:0xf bank_mask:0xf
    v_fmac_f32_dpp v22, v8, v30 row_newbcast:10 row_mask:0xf bank_mask:0xf
    v_fmac_f32_dpp v23, v8, v31 row_newbcast:10 row_mask:0xf bank_mask:0xf
    s_waitcnt vmcnt(7)
    v_lshlrev_b32 v24, 16, v108
    v_and_b32 v25, s80, v108
    v_lshlrev_b32 v26, 16, v109
    v_and_b32 v27, s80, v109
    v_lshlrev_b32 v28, 16, v110
    v_and_b32 v29, s80, v110
    v_lshlrev_b32 v30, 16, v111
    v_and_b32 v31, s80, v111
    v_fmac_f32_dpp v16, v8, v24 row_newbcast:11 row_mask:0xf bank_mask:0xf
    v_fmac_f32_dpp v17, v8, v25 row_newbcast:11 row_mask:0xf bank_mask:0xf
    v_fmac_f32_dpp v18, v8, v26 row_newbcast:11 row_mask:0xf bank_mask:0xf
    v_fmac_f32_dpp v19, v8, v27 row_newbcast:11 row_mask:0xf bank_mask:0xf
    v_fmac_f32_dpp v20, v8, v28 row_newbcast:11 row_mask:0xf bank_mask:0xf
    v_fmac_f32_dpp v21, v8, v29 row_newbcast:11 row_mask:0xf bank_mask:0xf
    v_fmac_f32_dpp v22, v8, v30 row_newbcast:11 row_mask:0xf bank_mask:0xf
    v_fmac_f32_dpp v23, v8, v31 row_newbcast:11 row_mask:0xf bank_mask:0xf
    s_waitcnt vmcnt(6)
    v_lshlrev_b32 v24, 16, v112
    v_and_b32 v25, s80, v112
    v_lshlrev_b32 v26, 16, v113
    v_and_b32 v27, s80, v113
    v_lshlrev_b32 v28, 16, v114
    v_and_b32 v29, s80, v114
    v_lshlrev_b32 v30, 16, v115
    v_and_b32 v31, s80, v115
    v_fmac_f32_dpp v16, v8, v24 row_newbcast:12 row_mask:0xf bank_mask:0xf
    v_fmac_f32_dpp v17, v8, v25 row_newbcast:12 row_mask:0xf bank_mask:0xf
    v_fmac_f32_dpp v18, v8, v26 row_newbcast:12 row_mask:0xf bank_mask:0xf
    v_fmac_f32_dpp v19, v8, v27 row_newbcast:12 row_mask:0xf bank_mask:0xf
    v_fmac_f32_dpp v20, v8, v28 row_newbcast:12 row_mask:0xf bank_mask:0xf
    v_fmac_f32_dpp v21, v8, v29 row_newbcast:12 row_mask:0xf bank_mask:0xf
    v_fmac_f32_dpp v22, v8, v30 row_newbcast:12 row_mask:0xf bank_mask:0xf
    v_fmac_f32_dpp v23, v8, v31 row_newbcast:12 row_mask:0xf bank_mask:0xf
    s_waitcnt vmcnt(5)
    v_lshlrev_b32 v24, 16, v116
    v_and_b32 v25, s80, v116
    v_lshlrev_b32 v26, 16, v117
    v_and_b32 v27, s80, v117
    v_lshlrev_b32 v28, 16, v118
    v_and_b32 v29, s80, v118
    v_lshlrev_b32 v30, 16, v119
    v_and_b32 v31, s80, v119
    v_fmac_f32_dpp v16, v8, v24 row_newbcast:13 row_mask:0xf bank_mask:0xf
    v_fmac_f32_dpp v17, v8, v25 row_newbcast:13 row_mask:0xf bank_mask:0xf
    v_fmac_f32_dpp v18, v8, v26 row_newbcast:13 row_mask:0xf bank_mask:0xf
    v_fmac_f32_dpp v19, v8, v27 row_newbcast:13 row_mask:0xf bank_mask:0xf
    v_fmac_f32_dpp v20, v8, v28 row_newbcast:13 row_mask:0xf bank_mask:0xf
    v_fmac_f32_dpp v21, v8, v29 row_newbcast:13 row_mask:0xf bank_mask:0xf
    v_fmac_f32_dpp v22, v8, v30 row_newbcast:13 row_mask:0xf bank_mask:0xf
    v_fmac_f32_dpp v23, v8, v31 row_newbcast:13 row_mask:0xf bank_mask:0xf
    s_waitcnt vmcnt(4)
    v_lshlrev_b32 v24, 16, v120
    v_and_b32 v25, s80, v120
    v_lshlrev_b32 v26, 16, v121
    v_and_b32 v27, s80, v121
    v_lshlrev_b32 v28, 16, v122
    v_and_b32 v29, s80, v122
    v_lshlrev_b32 v30, 16, v123
    v_and_b32 v31, s80, v123
    v_fmac_f32_dpp v16, v8, v24 row_newbcast:14 row_mask:0xf bank_mask:0xf
    v_fmac_f32_dpp v17, v8, v25 row_newbcast:14 row_mask:0xf bank_mask:0xf
    v_fmac_f32_dpp v18, v8, v26 row_newbcast:14 row_mask:0xf bank_mask:0xf
    v_fmac_f32_dpp v19, v8, v27 row_newbcast:14 row_mask:0xf bank_mask:0xf
    v_fmac_f32_dpp v20, v8, v28 row_newbcast:14 row_mask:0xf bank_mask:0xf
    v_fmac_f32_dpp v21, v8, v29 row_newbcast:14 row_mask:0xf bank_mask:0xf
    v_fmac_f32_dpp v22, v8, v30 row_newbcast:14 row_mask:0xf bank_mask:0xf
    v_fmac_f32_dpp v23, v8, v31 row_newbcast:14 row_mask:0xf bank_mask:0xf
    s_waitcnt vmcnt(3)
    v_lshlrev_b32 v24, 16, v124
    v_and_b32 v25, s80, v124
    v_lshlrev_b32 v26, 16, v125
    v_and_b32 v27, s80, v125
    v_lshlrev_b32 v28, 16, v126
    v_and_b32 v29, s80, v126
    v_lshlrev_b32 v30, 16, v127
    v_and_b32 v31, s80, v127
    v_fmac_f32_dpp v16, v8, v24 row_newbcast:15 row_mask:0xf bank_mask:0xf
    v_fmac_f32_dpp v17, v8, v25 row_newbcast:15 row_mask:0xf bank_mask:0xf
    v_fmac_f32_dpp v18, v8, v26 row_newbcast:15 row_mask:0xf bank_mask:0xf
    v_fmac_f32_dpp v19, v8, v27 row_newbcast:15 row_mask:0xf bank_mask:0xf
    v_fmac_f32_dpp v20, v8, v28 row_newbcast:15 row_mask:0xf bank_mask:0xf
    v_fmac_f32_dpp v21, v8, v29 row_newbcast:15 row_mask:0xf bank_mask:0xf
    v_fmac_f32_dpp v22, v8, v30 row_newbcast:15 row_mask:0xf bank_mask:0xf
    v_fmac_f32_dpp v23, v8, v31 row_newbcast:15 row_mask:0xf bank_mask:0xf
    v_mov_b32 v8, v9
    v_mov_b32 v9, v10
    v_mov_b32 v10, v11
    v_mov_b32 v11, v12
    s_mov_b32 s81, 2
L_vloop:
    s_cmp_eq_u32 s81, s82
    s_cselect_b32 s15, s99, 16
    s_cmp_le_u32 s15, 0
    s_cbranch_scc1 L_vdone
    s_waitcnt vmcnt(1)
    v_lshlrev_b32 v24, 16, v64
    v_and_b32 v25, s80, v64
    v_lshlrev_b32 v26, 16, v65
    v_and_b32 v27, s80, v65
    v_lshlrev_b32 v28, 16, v66
    v_and_b32 v29, s80, v66
    v_lshlrev_b32 v30, 16, v67
    v_and_b32 v31, s80, v67
    v_fmac_f32_dpp v16, v8, v24 row_newbcast:0 row_mask:0xf bank_mask:0xf
    v_fmac_f32_dpp v17, v8, v25 row_newbcast:0 row_mask:0xf bank_mask:0xf
    v_fmac_f32_dpp v18, v8, v26 row_newbcast:0 row_mask:0xf bank_mask:0xf
    v_fmac_f32_dpp v19, v8, v27 row_newbcast:0 row_mask:0xf bank_mask:0xf
    v_fmac_f32_dpp v20, v8, v28 row_newbcast:0 row_mask:0xf bank_mask:0xf
    v_fmac_f32_dpp v21, v8, v29 row_newbcast:0 row_mask:0xf bank_mask:0xf
    v_fmac_f32_dpp v22, v8, v30 row_newbcast:0 row_mask:0xf bank_mask:0xf
    v_fmac_f32_dpp v23, v8, v31 row_newbcast:0 row_mask:0xf bank_mask:0xf
    buffer_load_dwordx4 v[64:67], v1, s[68:71], s75 offen nt
    s_add_u32 s75, s75, 16384
    s_cmp_le_u32 s15, 1
    s_cbranch_scc1 L_vdone
    s_waitcnt vmcnt(1)
    v_lshlrev_b32 v24, 16, v68
    v_and_b32 v25, s80, v68
    v_lshlrev_b32 v26, 16, v69
    v_and_b32 v27, s80, v69
    v_lshlrev_b32 v28, 16, v70
    v_and_b32 v29, s80, v70
    v_lshlrev_b32 v30, 16, v71
    v_and_b32 v31, s80, v71
    v_fmac_f32_dpp v16, v8, v24 row_newbcast:1 row_mask:0xf bank_mask:0xf
    v_fmac_f32_dpp v17, v8, v25 row_newbcast:1 row_mask:0xf bank_mask:0xf
    v_fmac_f32_dpp v18, v8, v26 row_newbcast:1 row_mask:0xf bank_mask:0xf
    v_fmac_f32_dpp v19, v8, v27 row_newbcast:1 row_mask:0xf bank_mask:0xf
    v_fmac_f32_dpp v20, v8, v28 row_newbcast:1 row_mask:0xf bank_mask:0xf
    v_fmac_f32_dpp v21, v8, v29 row_newbcast:1 row_mask:0xf bank_mask:0xf
    v_fmac_f32_dpp v22, v8, v30 row_newbcast:1 row_mask:0xf bank_mask:0xf
    v_fmac_f32_dpp v23, v8, v31 row_newbcast:1 row_mask:0xf bank_mask:0xf
    buffer_load_dwordx4 v[68:71], v1, s[68:71], s75 offen nt
    s_add_u32 s75, s75, 16384
    s_cmp_le_u32 s15, 2
    s_cbranch_scc1 L_vdone
    s_waitcnt vmcnt(1)
    v_lshlrev_b32 v24, 16, v64
    v_and_b32 v25, s80, v64
    v_lshlrev_b32 v26, 16, v65
    v_and_b32 v27, s80, v65
    v_lshlrev_b32 v28, 16, v66
    v_and_b32 v29, s80, v66
    v_lshlrev_b32 v30, 16, v67
    v_and_b32 v31, s80, v67
    v_fmac_f32_dpp v16, v8, v24 row_newbcast:2 row_mask:0xf bank_mask:0xf
    v_fmac_f32_dpp v17, v8, v25 row_newbcast:2 row_mask:0xf bank_mask:0xf
    v_fmac_f32_dpp v18, v8, v26 row_newbcast:2 row_mask:0xf bank_mask:0xf
    v_fmac_f32_dpp v19, v8, v27 row_newbcast:2 row_mask:0xf bank_mask:0xf
    v_fmac_f32_dpp v20, v8, v28 row_newbcast:2 row_mask:0xf bank_mask:0xf
    v_fmac_f32_dpp v21, v8, v29 row_newbcast:2 row_mask:0xf bank_mask:0xf
    v_fmac_f32_dpp v22, v8, v30 row_newbcast:2 row_mask:0xf bank_mask:0xf
    v_fmac_f32_dpp v23, v8, v31 row_newbcast:2 row_mask:0xf bank_mask:0xf
    buffer_load_dwordx4 v[64:67], v1, s[68:71], s75 offen nt
    s_add_u32 s75, s75, 16384
    s_cmp_le_u32 s15, 3
    s_cbranch_scc1 L_vdone
    s_waitcnt vmcnt(1)
    v_lshlrev_b32 v24, 16, v68
    v_and_b32 v25, s80, v68
    v_lshlrev_b32 v26, 16, v69
    v_and_b32 v27, s80, v69
    v_lshlrev_b32 v28, 16, v70
    v_and_b32 v29, s80, v70
    v_lshlrev_b32 v30, 16, v71
    v_and_b32 v31, s80, v71
    v_fmac_f32_dpp v16, v8, v24 row_newbcast:3 row_mask:0xf bank_mask:0xf
    v_fmac_f32_dpp v17, v8, v25 row_newbcast:3 row_mask:0xf bank_mask:0xf
    v_fmac_f32_dpp v18, v8, v26 row_newbcast:3 row_mask:0xf bank_mask:0xf
    v_fmac_f32_dpp v19, v8, v27 row_newbcast:3 row_mask:0xf bank_mask:0xf
    v_fmac_f32_dpp v20, v8, v28 row_newbcast:3 row_mask:0xf bank_mask:0xf
    v_fmac_f32_dpp v21, v8, v29 row_newbcast:3 row_mask:0xf bank_mask:0xf
    v_fmac_f32_dpp v22, v8, v30 row_newbcast:3 row_mask:0xf bank_mask:0xf
    v_fmac_f32_dpp v23, v8, v31 row_newbcast:3 row_mask:0xf bank_mask:0xf
    buffer_load_dwordx4 v[68:71], v1, s[68:71], s75 offen nt
    s_add_u32 s75, s75, 16384
    s_cmp_le_u32 s15, 4
    s_cbranch_scc1 L_vdone
    s_waitcnt vmcnt(1)
    v_lshlrev_b32 v24, 16, v64
    v_and_b32 v25, s80, v64
    v_lshlrev_b32 v26, 16, v65
    v_and_b32 v27, s80, v65
    v_lshlrev_b32 v28, 16, v66
    v_and_b32 v29, s80, v66
    v_lshlrev_b32 v30, 16, v67
    v_and_b32 v31, s80, v67
    v_fmac_f32_dpp v16, v8, v24 row_newbcast:4 row_mask:0xf bank_mask:0xf
    v_fmac_f32_dpp v17, v8, v25 row_newbcast:4 row_mask:0xf bank_mask:0xf
    v_fmac_f32_dpp v18, v8, v26 row_newbcast:4 row_mask:0xf bank_mask:0xf
    v_fmac_f32_dpp v19, v8, v27 row_newbcast:4 row_mask:0xf bank_mask:0xf
    v_fmac_f32_dpp v20, v8, v28 row_newbcast:4 row_mask:0xf bank_mask:0xf
    v_fmac_f32_dpp v21, v8, v29 row_newbcast:4 row_mask:0xf bank_mask:0xf
    v_fmac_f32_dpp v22, v8, v30 row_newbcast:4 row_mask:0xf bank_mask:0xf
    v_fmac_f32_dpp v23, v8, v31 row_newbcast:4 row_mask:0xf bank_mask:0xf
    buffer_load_dwordx4 v[64:67], v1, s[68:71], s75 offen nt
    s_add_u32 s75, s75, 16384
    s_cmp_le_u32 s15, 5
    s_cbranch_scc1 L_vdone
    s_waitcnt vmcnt(1)
    v_lshlrev_b32 v24, 16, v68
    v_and_b32 v25, s80, v68
    v_lshlrev_b32 v26, 16, v69
    v_and_b32 v27, s80, v69
    v_lshlrev_b32 v28, 16, v70
    v_and_b32 v29, s80, v70
    v_lshlrev_b32 v30, 16, v71
    v_and_b32 v31, s80, v71
    v_fmac_f32_dpp v16, v8, v24 row_newbcast:5 row_mask:0xf bank_mask:0xf
    v_fmac_f32_dpp v17, v8, v25 row_newbcast:5 row_mask:0xf bank_mask:0xf
    v_fmac_f32_dpp v18, v8, v26 row_newbcast:5 row_mask:0xf bank_mask:0xf
    v_fmac_f32_dpp v19, v8, v27 row_newbcast:5 row_mask:0xf bank_mask:0xf
    v_fmac_f32_dpp v20, v8, v28 row_newbcast:5 row_mask:0xf bank_mask:0xf
    v_fmac_f32_dpp v21, v8, v29 row_newbcast:5 row_mask:0xf bank_mask:0xf
    v_fmac_f32_dpp v22, v8, v30 row_newbcast:5 row_mask:0xf bank_mask:0xf
    v_fmac_f32_dpp v23, v8, v31 row_newbcast:5 row_mask:0xf bank_mask:0xf
    buffer_load_dwordx4 v[68:71], v1, s[68:71], s75 offen nt
    s_add_u32 s75, s75, 16384
    s_cmp_le_u32 s15, 6
    s_cbranch_scc1 L_vdone
    s_waitcnt vmcnt(1)
    v_lshlrev_b32 v24, 16, v64
    v_and_b32 v25, s80, v64
    v_lshlrev_b32 v26, 16, v65
    v_and_b32 v27, s80, v65
    v_lshlrev_b32 v28, 16, v66
    v_and_b32 v29, s80, v66
    v_lshlrev_b32 v30, 16, v67
    v_and_b32 v31, s80, v67
    v_fmac_f32_dpp v16, v8, v24 row_newbcast:6 row_mask:0xf bank_mask:0xf
    v_fmac_f32_dpp v17, v8, v25 row_newbcast:6 row_mask:0xf bank_mask:0xf
    v_fmac_f32_dpp v18, v8, v26 row_newbcast:6 row_mask:0xf bank_mask:0xf
    v_fmac_f32_dpp v19, v8, v27 row_newbcast:6 row_mask:0xf bank_mask:0xf
    v_fmac_f32_dpp v20, v8, v28 row_newbcast:6 row_mask:0xf bank_mask:0xf
    v_fmac_f32_dpp v21, v8, v29 row_newbcast:6 row_mask:0xf bank_mask:0xf
    v_fmac_f32_dpp v22, v8, v30 row_newbcast:6 row_mask:0xf bank_mask:0xf
    v_fmac_f32_dpp v23, v8, v31 row_newbcast:6 row_mask:0xf bank_mask:0xf
    buffer_load_dwordx4 v[64:67], v1, s[68:71], s75 offen nt
    s_add_u32 s75, s75, 16384
    s_cmp_le_u32 s15, 7
    s_cbranch_scc1 L_vdone
    s_waitcnt vmcnt(1)
    v_lshlrev_b32 v24, 16, v68
    v_and_b32 v25, s80, v68
    v_lshlrev_b32 v26, 16, v69
    v_and_b32 v27, s80, v69
    v_lshlrev_b32 v28, 16, v70
    v_and_b32 v29, s80, v70
    v_lshlrev_b32 v30, 16, v71
    v_and_b32 v31, s80, v71
    v_fmac_f32_dpp v16, v8, v24 row_newbcast:7 row_mask:0xf bank_mask:0xf
    v_fmac_f32_dpp v17, v8, v25 row_newbcast:7 row_mask:0xf bank_mask:0xf
    v_fmac_f32_dpp v18, v8, v26 row_newbcast:7 row_mask:0xf bank_mask:0xf
    v_fmac_f32_dpp v19, v8, v27 row_newbcast:7 row_mask:0xf bank_mask:0xf
    v_fmac_f32_dpp v20, v8, v28 row_newbcast:7 row_mask:0xf bank_mask:0xf
    v_fmac_f32_dpp v21, v8, v29 row_newbcast:7 row_mask:0xf bank_mask:0xf
    v_fmac_f32_dpp v22, v8, v30 row_newbcast:7 row_mask:0xf bank_mask:0xf
    v_fmac_f32_dpp v23, v8, v31 row_newbcast:7 row_mask:0xf bank_mask:0xf
    buffer_load_dwordx4 v[68:71], v1, s[68:71], s75 offen nt
    s_add_u32 s75, s75, 16384
    s_cmp_le_u32 s15, 8
    s_cbranch_scc1 L_vdone
    s_waitcnt vmcnt(1)
    v_lshlrev_b32 v24, 16, v64
    v_and_b32 v25, s80, v64
    v_lshlrev_b32 v26, 16, v65
    v_and_b32 v27, s80, v65
    v_lshlrev_b32 v28, 16, v66
    v_and_b32 v29, s80, v66
    v_lshlrev_b32 v30, 16, v67
    v_and_b32 v31, s80, v67
    v_fmac_f32_dpp v16, v8, v24 row_newbcast:8 row_mask:0xf bank_mask:0xf
    v_fmac_f32_dpp v17, v8, v25 row_newbcast:8 row_mask:0xf bank_mask:0xf
    v_fmac_f32_dpp v18, v8, v26 row_newbcast:8 row_mask:0xf bank_mask:0xf
    v_fmac_f32_dpp v19, v8, v27 row_newbcast:8 row_mask:0xf bank_mask:0xf
    v_fmac_f32_dpp v20, v8, v28 row_newbcast:8 row_mask:0xf bank_mask:0xf
    v_fmac_f32_dpp v21, v8, v29 row_newbcast:8 row_mask:0xf bank_mask:0xf
    v_fmac_f32_dpp v22, v8, v30 row_newbcast:8 row_mask:0xf bank_mask:0xf
    v_fmac_f32_dpp v23, v8, v31 row_newbcast:8 row_mask:0xf bank_mask:0xf
    buffer_load_dwordx4 v[64:67], v1, s[68:71], s75 offen nt
    s_add_u32 s75, s75, 16384
    s_cmp_le_u32 s15, 9
    s_cbranch_scc1 L_vdone
    s_waitcnt vmcnt(1)
    v_lshlrev_b32 v24, 16, v68
    v_and_b32 v25, s80, v68
    v_lshlrev_b32 v26, 16, v69
    v_and_b32 v27, s80, v69
    v_lshlrev_b32 v28, 16, v70
    v_and_b32 v29, s80, v70
    v_lshlrev_b32 v30, 16, v71
    v_and_b32 v31, s80, v71
    v_fmac_f32_dpp v16, v8, v24 row_newbcast:9 row_mask:0xf bank_mask:0xf
    v_fmac_f32_dpp v17, v8, v25 row_newbcast:9 row_mask:0xf bank_mask:0xf
    v_fmac_f32_dpp v18, v8, v26 row_newbcast:9 row_mask:0xf bank_mask:0xf
    v_fmac_f32_dpp v19, v8, v27 row_newbcast:9 row_mask:0xf bank_mask:0xf
    v_fmac_f32_dpp v20, v8, v28 row_newbcast:9 row_mask:0xf bank_mask:0xf
    v_fmac_f32_dpp v21, v8, v29 row_newbcast:9 row_mask:0xf bank_mask:0xf
    v_fmac_f32_dpp v22, v8, v30 row_newbcast:9 row_mask:0xf bank_mask:0xf
    v_fmac_f32_dpp v23, v8, v31 row_newbcast:9 row_mask:0xf bank_mask:0xf
    buffer_load_dwordx4 v[68:71], v1, s[68:71], s75 offen nt
    s_add_u32 s75, s75, 16384
    s_cmp_le_u32 s15, 10
    s_cbranch_scc1 L_vdone
    s_waitcnt vmcnt(1)
    v_lshlrev_b32 v24, 16, v64
    v_and_b32 v25, s80, v64
    v_lshlrev_b32 v26, 16, v65
    v_and_b32 v27, s80, v65
    v_lshlrev_b32 v28, 16, v66
    v_and_b32 v29, s80, v66
    v_lshlrev_b32 v30, 16, v67
    v_and_b32 v31, s80, v67
    v_fmac_f32_dpp v16, v8, v24 row_newbcast:10 row_mask:0xf bank_mask:0xf
    v_fmac_f32_dpp v17, v8, v25 row_newbcast:10 row_mask:0xf bank_mask:0xf
    v_fmac_f32_dpp v18, v8, v26 row_newbcast:10 row_mask:0xf bank_mask:0xf
    v_fmac_f32_dpp v19, v8, v27 row_newbcast:10 row_mask:0xf bank_mask:0xf
    v_fmac_f32_dpp v20, v8, v28 row_newbcast:10 row_mask:0xf bank_mask:0xf
    v_fmac_f32_dpp v21, v8, v29 row_newbcast:10 row_mask:0xf bank_mask:0xf
    v_fmac_f32_dpp v22, v8, v30 row_newbcast:10 row_mask:0xf bank_mask:0xf
    v_fmac_f32_dpp v23, v8, v31 row_newbcast:10 row_mask:0xf bank_mask:0xf
    buffer_load_dwordx4 v[64:67], v1, s[68:71], s75 offen nt
    s_add_u32 s75, s75, 16384
    s_cmp_le_u32 s15, 11
    s_cbranch_scc1 L_vdone
    s_waitcnt vmcnt(1)
    v_lshlrev_b32 v24, 16, v68
    v_and_b32 v25, s80, v68
    v_lshlrev_b32 v26, 16, v69
    v_and_b32 v27, s80, v69
    v_lshlrev_b32 v28, 16, v70
    v_and_b32 v29, s80, v70
    v_lshlrev_b32 v30, 16, v71
    v_and_b32 v31, s80, v71
    v_fmac_f32_dpp v16, v8, v24 row_newbcast:11 row_mask:0xf bank_mask:0xf
    v_fmac_f32_dpp v17, v8, v25 row_newbcast:11 row_mask:0xf bank_mask:0xf
    v_fmac_f32_dpp v18, v8, v26 row_newbcast:11 row_mask:0xf bank_mask:0xf
    v_fmac_f32_dpp v19, v8, v27 row_newbcast:11 row_mask:0xf bank_mask:0xf
    v_fmac_f32_dpp v20, v8, v28 row_newbcast:11 row_mask:0xf bank_mask:0xf
    v_fmac_f32_dpp v21, v8, v29 row_newbcast:11 row_mask:0xf bank_mask:0xf
    v_fmac_f32_dpp v22, v8, v30 row_newbcast:11 row_mask:0xf bank_mask:0xf
    v_fmac_f32_dpp v23, v8, v31 row_newbcast:11 row_mask:0xf bank_mask:0xf
    buffer_load_dwordx4 v[68:71], v1, s[68:71], s75 offen nt
    s_add_u32 s75, s75, 16384
    s_cmp_le_u32 s15, 12
    s_cbranch_scc1 L_vdone
    s_waitcnt vmcnt(1)
    v_lshlrev_b32 v24, 16, v64
    v_and_b32 v25, s80, v64
    v_lshlrev_b32 v26, 16, v65
    v_and_b32 v27, s80, v65
    v_lshlrev_b32 v28, 16, v66
    v_and_b32 v29, s80, v66
    v_lshlrev_b32 v30, 16, v67
    v_and_b32 v31, s80, v67
    v_fmac_f32_dpp v16, v8, v24 row_newbcast:12 row_mask:0xf bank_mask:0xf
    v_fmac_f32_dpp v17, v8, v25 row_newbcast:12 row_mask:0xf bank_mask:0xf
    v_fmac_f32_dpp v18, v8, v26 row_newbcast:12 row_mask:0xf bank_mask:0xf
    v_fmac_f32_dpp v19, v8, v27 row_newbcast:12 row_mask:0xf bank_mask:0xf
    v_fmac_f32_dpp v20, v8, v28 row_newbcast:12 row_mask:0xf bank_mask:0xf
    v_fmac_f32_dpp v21, v8, v29 row_newbcast:12 row_mask:0xf bank_mask:0xf
    v_fmac_f32_dpp v22, v8, v30 row_newbcast:12 row_mask:0xf bank_mask:0xf
    v_fmac_f32_dpp v23, v8, v31 row_newbcast:12 row_mask:0xf bank_mask:0xf
    buffer_load_dwordx4 v[64:67], v1, s[68:71], s75 offen nt
    s_add_u32 s75, s75, 16384
    s_cmp_le_u32 s15, 13
    s_cbranch_scc1 L_vdone
    s_waitcnt vmcnt(1)
    v_lshlrev_b32 v24, 16, v68
    v_and_b32 v25, s80, v68
    v_lshlrev_b32 v26, 16, v69
    v_and_b32 v27, s80, v69
    v_lshlrev_b32 v28, 16, v70
    v_and_b32 v29, s80, v70
    v_lshlrev_b32 v30, 16, v71
    v_and_b32 v31, s80, v71
    v_fmac_f32_dpp v16, v8, v24 row_newbcast:13 row_mask:0xf bank_mask:0xf
    v_fmac_f32_dpp v17, v8, v25 row_newbcast:13 row_mask:0xf bank_mask:0xf
    v_fmac_f32_dpp v18, v8, v26 row_newbcast:13 row_mask:0xf bank_mask:0xf
    v_fmac_f32_dpp v19, v8, v27 row_newbcast:13 row_mask:0xf bank_mask:0xf
    v_fmac_f32_dpp v20, v8, v28 row_newbcast:13 row_mask:0xf bank_mask:0xf
    v_fmac_f32_dpp v21, v8, v29 row_newbcast:13 row_mask:0xf bank_mask:0xf
    v_fmac_f32_dpp v22, v8, v30 row_newbcast:13 row_mask:0xf bank_mask:0xf
    v_fmac_f32_dpp v23, v8, v31 row_newbcast:13 row_mask:0xf bank_mask:0xf
    buffer_load_dwordx4 v[68:71], v1, s[68:71], s75 offen nt
    s_add_u32 s75, s75, 16384
    s_cmp_le_u32 s15, 14
    s_cbranch_scc1 L_vdone
    s_cmp_lg_u32 s81, s82
    s_cbranch_scc1 L_v1
    s_mov_b32 s70, 0
L_v1:
    s_waitcnt vmcnt(1)
    v_lshlrev_b32 v24, 16, v64
    v_and_b32 v25, s80, v64
    v_lshlrev_b32 v26, 16, v65
    v_and_b32 v27, s80, v65
    v_lshlrev_b32 v28, 16, v66
    v_and_b32 v29, s80, v66
    v_lshlrev_b32 v30, 16, v67
    v_and_b32 v31, s80, v67
    v_fmac_f32_dpp v16, v8, v24 row_newbcast:14 row_mask:0xf bank_mask:0xf
    v_fmac_f32_dpp v17, v8, v25 row_newbcast:14 row_mask:0xf bank_mask:0xf
    v_fmac_f32_dpp v18, v8, v26 row_newbcast:14 row_mask:0xf bank_mask:0xf
    v_fmac_f32_dpp v19, v8, v27 row_newbcast:14 row_mask:0xf bank_mask:0xf
    v_fmac_f32_dpp v20, v8, v28 row_newbcast:14 row_mask:0xf bank_mask:0xf
    v_fmac_f32_dpp v21, v8, v29 row_newbcast:14 row_mask:0xf bank_mask:0xf
    v_fmac_f32_dpp v22, v8, v30 row_newbcast:14 row_mask:0xf bank_mask:0xf
    v_fmac_f32_dpp v23, v8, v31 row_newbcast:14 row_mask:0xf bank_mask:0xf
    buffer_load_dwordx4 v[64:67], v1, s[68:71], s75 offen nt
    s_add_u32 s75, s75, 16384
    s_cmp_le_u32 s15, 15
    s_cbranch_scc1 L_vdone
    s_waitcnt vmcnt(1)
    v_lshlrev_b32 v24, 16, v68
    v_and_b32 v25, s80, v68
    v_lshlrev_b32 v26, 16, v69
    v_and_b32 v27, s80, v69
    v_lshlrev_b32 v28, 16, v70
    v_and_b32 v29, s80, v70
    v_lshlrev_b32 v30, 16, v71
    v_and_b32 v31, s80, v71
    v_fmac_f32_dpp v16, v8, v24 row_newbcast:15 row_mask:0xf bank_mask:0xf
    v_fmac_f32_dpp v17, v8, v25 row_newbcast:15 row_mask:0xf bank_mask:0xf
    v_fmac_f32_dpp v18, v8, v26 row_newbcast:15 row_mask:0xf bank_mask:0xf
    v_fmac_f32_dpp v19, v8, v27 row_newbcast:15 row_mask:0xf bank_mask:0xf
    v_fmac_f32_dpp v20, v8, v28 row_newbcast:15 row_mask:0xf bank_mask:0xf
    v_fmac_f32_dpp v21, v8, v29 row_newbcast:15 row_mask:0xf bank_mask:0xf
    v_fmac_f32_dpp v22, v8, v30 row_newbcast:15 row_mask:0xf bank_mask:0xf
    v_fmac_f32_dpp v23, v8, v31 row_newbcast:15 row_mask:0xf bank_mask:0xf
    buffer_load_dwordx4 v[68:71], v1, s[68:71], s75 offen nt
    s_add_u32 s75, s75, 16384
    v_mov_b32 v8, v9
    v_mov_b32 v9, v10
    v_mov_b32 v10, v11
    v_mov_b32 v11, v12
    s_cmp_lg_u32 s3, 15
    s_cbranch_scc1 L_ev3
    s_lshl_b32 s76, s72, 6
    s_add_u32 s76, s76, 49152
    s_cmp_lg_u32 s81, 2
    s_cbranch_scc1 L_ev2
    buffer_load_dwordx2 v[14:15], v13, s[64:67], s76 offen sc1
L_ev2:
    s_cmp_lg_u32 s81, 3
    s_cbranch_scc1 L_ev3
    s_mov_b32 s97, 0
L_spoll:
    s_add_u32 s97, s97, 1
    s_cmp_gt_u32 s97, 20000
    s_cbranch_scc1 L_ev3
    v_cmp_eq_u32 vcc, 0, v15
    s_cbranch_vccz L_ev3
    s_sleep 64
    buffer_load_dwordx2 v[14:15], v13, s[64:67], s76 offen sc1
    s_waitcnt vmcnt(0)
    s_branch L_spoll
L_ev3:
    s_add_u32 s81, s81, 1
    s_cmp_le_u32 s81, s82
    s_cbranch_scc1 L_vloop
L_vdone:
    s_waitcnt vmcnt(0)
    s_cmp_lg_u32 s3, 15
    s_cbranch_scc1 L_nog
    v_mov_b32 v2, v14
    s_nop 1
    v_max_f32_dpp v2, v2, v2 row_ror:4 row_mask:0xf bank_mask:0xf
    s_nop 1
    v_max_f32_dpp v2, v2, v2 row_ror:2 row_mask:0xf bank_mask:0xf
    s_nop 1
    v_max_f32_dpp v2, v2, v2 row_ror:1 row_mask:0xf bank_mask:0xf
    v_sub_f32 v14, v14, v2
    v_sub_f32 v24, s79, v2
    v_mul_f32 v14, 0x3fb8aa3b, v14
    v_mul_f32 v24, 0x3fb8aa3b, v24
    v_exp_f32 v14, v14
    v_exp_f32 v24, v24
    s_nop 0
    v_mul_f32 v3, v14, v15
    s_nop 1
    v_add_f32_dpp v3, v3, v3 row_ror:4 row_mask:0xf bank_mask:0xf
    s_nop 1
    v_add_f32_dpp v3, v3, v3 row_ror:2 row_mask:0xf bank_mask:0xf
    s_nop 1
    v_add_f32_dpp v3, v3, v3 row_ror:1 row_mask:0xf bank_mask:0xf
    v_rcp_f32 v3, v3
    s_nop 0
    v_mul_f32 v3, v3, v24
    v_mov_b32 v2, 8448
    ds_write_b32 v2, v3 offset:8
L_nog:
    s_nop 1
    v_permlane32_swap_b32 v16, v20
    v_permlane32_swap_b32 v17, v21
    v_permlane32_swap_b32 v18, v22
    v_permlane32_swap_b32 v19, v23
    s_nop 0
    v_add_f32 v16, v16, v20
    v_add_f32 v17, v17, v21
    v_add_f32 v18, v18, v22
    v_add_f32 v19, v19, v23
    s_nop 1
    v_permlane16_swap_b32 v16, v18
    v_permlane16_swap_b32 v17, v19
    s_nop 0
    v_add_f32 v16, v16, v18
    v_add_f32 v17, v17, v19
    v_and_b32 v2, 15, v0
    v_lshlrev_b32 v2, 5, v2
    v_lshrrev_b32 v3, 4, v0
    v_lshl_add_u32 v15, v3, 3, v2
    s_mul_i32 s76, s3, 528
    v_add_u32 v2, s76, v15
    ds_write_b64 v2, v[16:17] offset:10752
    v_lshlrev_b32 v24, 16, v44
    v_and_b32 v25, s80, v44
    v_lshlrev_b32 v26, 16, v45
    v_and_b32 v27, s80, v45
    v_lshlrev_b32 v28, 16, v46
    v_and_b32 v29, s80, v46
    v_lshlrev_b32 v30, 16, v47
    v_and_b32 v31, s80, v47
    s_waitcnt lgkmcnt(0)
    s_barrier
    s_cmp_lg_u32 s3, 0
    s_cbranch_scc1 L_noom
    ds_read_b64 v[64:65], v15 offset:10752
    ds_read_b64 v[66:67], v15 offset:11280
    ds_read_b64 v[68:69], v15 offset:11808
    ds_read_b64 v[70:71], v15 offset:12336
    ds_read_b64 v[72:73], v15 offset:12864
    ds_read_b64 v[74:75], v15 offset:13392
    ds_read_b64 v[76:77], v15 offset:13920
    ds_read_b64 v[78:79], v15 offset:14448
    ds_read_b64 v[80:81], v15 offset:14976
    ds_read_b64 v[82:83], v15 offset:15504
    ds_read_b64 v[84:85], v15 offset:16032
    ds_read_b64 v[86:87], v15 offset:16560
    ds_read_b64 v[88:89], v15 offset:17088
    ds_read_b64 v[90:91], v15 offset:17616
    ds_read_b64 v[92:93], v15 offset:18144
    ds_read_b64 v[94:95], v15 offset:18672
    v_mov_b32 v3, 8448
    ds_read_b32 v3, v3 offset:8
    s_waitcnt lgkmcnt(0)
    v_add_f32 v64, v64, v66
    v_add_f32 v65, v65, v67
    v_add_f32 v64, v64, v68
    v_add_f32 v65, v65, v69
    v_add_f32 v64, v64, v70
    v_add_f32 v65, v65, v71
    v_add_f32 v64, v64, v72
    v_add_f32 v65, v65, v73
    v_add_f32 v64, v64, v74
    v_add_f32 v65, v65, v75
    v_add_f32 v64, v64, v76
    v_add_f32 v65, v65, v77
    v_add_f32 v64, v64, v78
    v_add_f32 v65, v65, v79
    v_add_f32 v64, v64, v80
    v_add_f32 v65, v65, v81
    v_add_f32 v64, v64, v82
    v_add_f32 v65, v65, v83
    v_add_f32 v64, v64, v84
    v_add_f32 v65, v65, v85
    v_add_f32 v64, v64, v86
    v_add_f32 v65, v65, v87
    v_add_f32 v64, v64, v88
    v_add_f32 v65, v65, v89
    v_add_f32 v64, v64, v90
    v_add_f32 v65, v65, v91
    v_add_f32 v64, v64, v92
    v_add_f32 v65, v65, v93
    v_add_f32 v64, v64, v94
    v_add_f32 v65, v65, v95
    v_mul_f32 v64, v64, v3
    v_mul_f32 v65, v65, v3
    v_not_b32 v64, v64
    v_not_b32 v65, v65
    s_lshl_b32 s76, s72, 3
    s_add_u32 s76, s76, s73
    s_lshl_b32 s76, s76, 9
    s_add_u32 s76, s76, 184320
    buffer_store_dwordx2 v[64:65], v15, s[64:67], s76 offen sc1
L_noom:
    v_and_b32 v2, 7, v0
    v_lshlrev_b32 v2, 9, v2
    s_lshl_b32 s76, s72, 12
    s_lshl_b32 s77, s73, 6
    s_add_u32 s76, s76, s77
    s_lshl_b32 s77, s3, 2
    s_add_u32 s76, s76, s77
    s_add_u32 s76, s76, 184320
    s_mov_b32 s97, 0
L_opoll:
    buffer_load_dword v3, v2, s[64:67], s76 offen sc1
    s_waitcnt vmcnt(0)
    s_add_u32 s97, s97, 1
    s_cmp_gt_u32 s97, 20000
    s_cbranch_scc1 L_ook
    v_cmp_eq_u32 vcc, 0, v3
    s_cbranch_vccz L_ook
    s_sleep 2
    s_branch L_opoll
L_ook:
    v_not_b32 v3, v3
    s_nop 1
    v_add_f32_dpp v3, v3, v3 quad_perm:[1,0,3,2] row_mask:0xf bank_mask:0xf
    s_nop 1
    v_add_f32_dpp v3, v3, v3 quad_perm:[2,3,0,1] row_mask:0xf bank_mask:0xf
    s_nop 1
    v_add_f32_dpp v3, v3, v3 row_half_mirror row_mask:0xf bank_mask:0xf
    v_mul_f32 v16, v3, v24
    v_mul_f32 v17, v3, v25
    v_mul_f32 v18, v3, v26
    v_mul_f32 v19, v3, v27
    v_mul_f32 v20, v3, v28
    v_mul_f32 v21, v3, v29
    v_mul_f32 v22, v3, v30
    v_mul_f32 v23, v3, v31
    s_lshl_b32 s76, s3, 11
    v_add_u32 v2, s76, v1
    ds_write_b128 v2, v[16:19] offset:19200
    ds_write_b128 v2, v[20:23] offset:20224
    s_waitcnt lgkmcnt(0)
    s_barrier
    s_and_b32 s77, s3, 7
    s_lshl_b32 s76, s77, 8
    v_lshlrev_b32 v2, 2, v0
    v_add_u32 v2, s76, v2
    s_cmp_ge_u32 s3, 8
    s_cbranch_scc1 L_t4f
    ds_read_b32 v64, v2 offset:19200
    ds_read_b32 v65, v2 offset:21248
    ds_read_b32 v66, v2 offset:23296
    ds_read_b32 v67, v2 offset:25344
    ds_read_b32 v68, v2 offset:27392
    ds_read_b32 v69, v2 offset:29440
    ds_read_b32 v70, v2 offset:31488
    ds_read_b32 v71, v2 offset:33536
    ds_read_b32 v72, v2 offset:35584
    ds_read_b32 v73, v2 offset:37632
    ds_read_b32 v74, v2 offset:39680
    ds_read_b32 v75, v2 offset:41728
    ds_read_b32 v76, v2 offset:43776
    ds_read_b32 v77, v2 offset:45824
    ds_read_b32 v78, v2 offset:47872
    ds_read_b32 v79, v2 offset:49920
    s_waitcnt lgkmcnt(0)
    v_add_f32 v64, v64, v65
    v_add_f32 v64, v64, v66
    v_add_f32 v64, v64, v67
    v_add_f32 v64, v64, v68
    v_add_f32 v64, v64, v69
    v_add_f32 v64, v64, v70
    v_add_f32 v64, v64, v71
    v_add_f32 v64, v64, v72
    v_add_f32 v64, v64, v73
    v_add_f32 v64, v64, v74
    v_add_f32 v64, v64, v75
    v_add_f32 v64, v64, v76
    v_add_f32 v64, v64, v77
    v_add_f32 v64, v64, v78
    v_add_f32 v64, v64, v79
    s_lshl_b32 s76, s73, 11
    buffer_atomic_add_f32 v64, v2, s[64:67], s76 offen offset:0
    s_branch L_t4c
L_t4f:
    s_cmp_eq_u32 s78, 0xffff
    s_cbranch_scc1 L_t4c
    ds_read_b32 v64, v2 offset:8704
    s_waitcnt lgkmcnt(0)
    s_lshl_b32 s76, s73, 11
    s_add_u32 s76, s76, 16384
    buffer_atomic_add_f32 v64, v2, s[64:67], s76 offen
L_t4c:
    s_waitcnt vmcnt(0)
    s_lshl_b32 s76, s73, 3
    s_add_u32 s76, s76, s77
    s_lshl_b32 s76, s76, 8
    s_add_u32 s76, s76, 32768
    v_mov_b32 v3, 1
    s_mov_b64 exec, 1
    buffer_atomic_add v3, off, s[64:67], s76
    s_mov_b64 exec, -1
    s_cmp_lg_u32 s2, 0
    s_cbranch_scc1 L_end
    s_cmp_ge_u32 s3, 8
    s_cbranch_scc1 L_end
    v_and_b32 v3, 7, v0
    v_lshlrev_b32 v3, 11, v3
    s_lshl_b32 s76, s3, 8
    s_add_u32 s76, s76, 32768
    s_mov_b32 s97, 0
L_fpoll:
    s_add_u32 s97, s97, 1
    s_cmp_gt_u32 s97, 20000
    s_cbranch_scc1 L_fok
    buffer_load_dword v24, v3, s[64:67], s76 offen sc1
    s_waitcnt vmcnt(0)
    v_cmp_ne_u32 vcc, 64, v24
    s_cbranch_vccz L_fok
    s_sleep 2
    s_branch L_fpoll
L_fok:
    s_mov_b32 s76, 0
    buffer_load_dword v64, v2, s[64:67], s76 offen sc1
    s_mov_b32 s76, 2048
    buffer_load_dword v65, v2, s[64:67], s76 offen sc1
    s_mov_b32 s76, 4096
    buffer_load_dword v66, v2, s[64:67], s76 offen sc1
    s_mov_b32 s76, 6144
    buffer_load_dword v67, v2, s[64:67], s76 offen sc1
    s_mov_b32 s76, 8192
    buffer_load_dword v68, v2, s[64:67], s76 offen sc1
    s_mov_b32 s76, 10240
    buffer_load_dword v69, v2, s[64:67], s76 offen sc1
    s_mov_b32 s76, 12288
    buffer_load_dword v70, v2, s[64:67], s76 offen sc1
    s_mov_b32 s76, 14336
    buffer_load_dword v71, v2, s[64:67], s76 offen sc1
    s_mov_b32 s76, 16384
    buffer_load_dword v72, v2, s[64:67], s76 offen sc1
    s_mov_b32 s76, 18432
    buffer_load_dword v73, v2, s[64:67], s76 offen sc1
    s_mov_b32 s76, 20480
    buffer_load_dword v74, v2, s[64:67], s76 offen sc1
    s_mov_b32 s76, 22528
    buffer_load_dword v75, v2, s[64:67], s76 offen sc1
    s_mov_b32 s76, 24576
    buffer_load_dword v76, v2, s[64:67], s76 offen sc1
    s_mov_b32 s76, 26624
    buffer_load_dword v77, v2, s[64:67], s76 offen sc1
    s_mov_b32 s76, 28672
    buffer_load_dword v78, v2, s[64:67], s76 offen sc1
    s_mov_b32 s76, 30720
    buffer_load_dword v79, v2, s[64:67], s76 offen sc1
    v_lshrrev_b32 v3, 2, v2
    v_and_b32 v24, 3, v3
    v_bfe_u32 v25, v3, 2, 6
    v_lshl_add_u32 v24, v25, 3, v24
    v_lshrrev_b32 v25, 8, v3
    v_lshl_add_u32 v24, v25, 2, v24
    v_lshlrev_b32 v24, 1, v24
    buffer_load_ushort v25, v24, s[44:47], 0 offen
    s_waitcnt vmcnt(0)
    v_add_f32 v64, v64, v65
    v_add_f32 v64, v64, v66
    v_add_f32 v64, v64, v67
    v_add_f32 v64, v64, v68
    v_add_f32 v64, v64, v69
    v_add_f32 v64, v64, v70
    v_add_f32 v64, v64, v71
    v_add_f32 v72, v72, v73
    v_add_f32 v72, v72, v74
    v_add_f32 v72, v72, v75
    v_add_f32 v72, v72, v76
    v_add_f32 v72, v72, v77
    v_add_f32 v72, v72, v78
    v_add_f32 v72, v72, v79
    v_cvt_pk_bf16_f32 v64, v64, v64
    v_lshlrev_b32 v64, 16, v64
    v_cvt_pk_bf16_f32 v72, v72, v72
    v_lshlrev_b32 v72, 16, v72
    v_lshlrev_b32 v25, 16, v25
    v_add_f32 v64, v64, v25
    v_cvt_pk_bf16_f32 v64, v64, v64
    v_lshlrev_b32 v64, 16, v64
    v_add_f32 v64, v64, v72
    v_cvt_pk_bf16_f32 v64, v64, v64
    buffer_store_short v64, v24, s[56:59], 0 offen
L_end:
    s_endpgm
.section .rodata,"a"
.p2align 6
.amdhsa_kernel parallel_sum__mha_block_cached__geglu_ffn__decode_kernel
  .amdhsa_next_free_vgpr 128
  .amdhsa_next_free_sgpr 102
  .amdhsa_accum_offset 128
  .amdhsa_group_segment_fixed_size 0
  .amdhsa_kernarg_size 96
  .amdhsa_user_sgpr_count 2
  .amdhsa_user_sgpr_kernarg_segment_ptr 1
  .amdhsa_system_sgpr_workgroup_id_x 1
.end_amdhsa_kernel
```
